```python
import torch

def _softmax(x, axis=-1):
    return torch.softmax(x, dim=axis)
def _gelu(x):
    return torch.nn.functional.gelu(x, approximate="tanh")
def _silu(x):
    return torch.nn.functional.silu(x)
def _sigmoid(x):
    return torch.sigmoid(x)
def _layernorm(x, axis=-1, eps=1e-5):
    m = x.mean(dim=axis, keepdim=True)
    v = x.var(dim=axis, keepdim=True, unbiased=False)
    return (x - m) / torch.sqrt(v + eps)
def _scatter_add(tgt, idx, src, axis=0):
    return tgt.clone().index_add_(axis, idx, src)
def _segment_sum(src, seg, n):
    out = torch.zeros((n,) + src.shape[1:], dtype=src.dtype)
    return out.index_add_(0, seg, src)
def _pad(x, pw):
    flat = tuple(v for pair in reversed(pw) for v in pair)
    return torch.nn.functional.pad(x, flat)

kernel_name = 'standalone__gqa_block_cached__decode'

def setup_inputs():

    _w = (lambda a: (lambda t: t.to(torch.bfloat16) if t.is_floating_point() else t)(torch.as_tensor(a)))
    B, Sq, D = 1, 1, 640
    Hq, Hkv, Sk, Dh = 32, 32, 8192, 192
    assert Hq % Hkv == 0, (Hq, Hkv)
    return {
        "x": _w((lambda *s: torch.randn(*s, dtype=torch.bfloat16) * 0.8)(B, Sq, D)),
        "k_cache": _w((lambda *s: torch.randn(*s, dtype=torch.bfloat16) * 0.8)(B, Hkv, Sk, Dh)),
        "v_cache": _w((lambda *s: torch.randn(*s, dtype=torch.bfloat16) * 0.05)(B, Hkv, Sk, Dh)),
        "wq": _w((lambda *s: torch.randn(*s, dtype=torch.bfloat16) * 0.8)(D, Hq * Dh) * (D ** -0.5)),
        "wo": _w((lambda *s: torch.randn(*s, dtype=torch.bfloat16) * 0.05)(Hq * Dh, D) * ((Hq * Dh) ** -0.5)),
    }

def reference(x, k_cache, v_cache, wq, wo):
    B, Sq, D = x.shape
    Hq, Dh = 32, 192
    Hkv = k_cache.shape[1]
    rep = Hq // Hkv
    q = (lambda x, *d: x.permute(*d))((x @ wq).reshape(B, Sq, Hq, Dh), 0, 2, 1, 3)
    k = (lambda x, n, axis: torch.repeat_interleave(x, n, dim=axis))(k_cache, rep, axis=1)
    v = (lambda x, n, axis: torch.repeat_interleave(x, n, dim=axis))(v_cache, rep, axis=1)
    scores = torch.einsum("bhqd,bhkd->bhqk", q, k) * (Dh ** -0.5)
    p = _softmax(scores, axis=-1)
    o = torch.einsum("bhqk,bhkd->bhqd", p, v)
    return (lambda x, *d: x.permute(*d))(o, 0, 2, 1, 3).reshape(B, Sq, Hq * Dh) @ wo
```

```asm
; @launch grid=(256,1,1) block=(512,1,1) lds=16384
.amdgcn_target "amdgcn-amd-amdhsa--gfx950"
.text
.globl standalone__gqa_block_cached__decode_kernel
.p2align 8
.type standalone__gqa_block_cached__decode_kernel,@function
standalone__gqa_block_cached__decode_kernel:
    s_cmp_ge_u32 s2, 256
    s_cbranch_scc1 L_end
    s_load_dwordx16 s[4:19], s[0:1], 0
    v_and_b32 v1, 63, v0
    v_lshrrev_b32 v3, 6, v0
    s_and_b32 s56, s2, 7
    s_lshr_b32 s57, s2, 3
    v_readfirstlane_b32 s22, v3
    s_and_b32 s58, s57, 3
    s_lshl_b32 s56, s56, 2
    s_add_u32 s20, s56, s58
    s_lshr_b32 s21, s57, 2
    v_lshrrev_b32 v9, 3, v1
    v_and_b32 v10, 7, v1
    v_lshlrev_b32 v11, 4, v10
    v_mul_u32_u24 v2, 384, v9
    v_add_u32 v2, v2, v11
    s_mul_i32 s56, s22, 3072
    v_add_u32 v2, s56, v2
    v_mul_u32_u24 v3, 122880, v9
    v_add_u32 v3, v3, v11
    v_mul_u32_u24 v4, 20, v9
    s_mul_i32 s58, s20, 3145728
    s_mul_i32 s59, s21, 24576
    s_add_u32 s58, s58, s59
    s_waitcnt lgkmcnt(0)
    s_cmp_lg_u32 s22, 0
    s_cbranch_scc1 L_notsvc
    s_setprio 3
    s_mul_i32 s57, s21, 80
    s_lshl_b32 s56, s57, 1
    s_add_u32 s24, s4, s56
    s_addc_u32 s25, s5, 0
    s_and_b32 s25, s25, 0xffff
    s_mov_b32 s26, 160
    s_mov_b32 s27, 0x20000
    s_mul_i32 s56, s57, 12288
    s_mul_i32 s57, s20, 384
    s_add_u32 s56, s56, s57
    s_add_u32 s28, s10, s56
    s_addc_u32 s29, s11, 0
    s_and_b32 s29, s29, 0xffff
    s_mov_b32 s30, 971136
    s_mov_b32 s31, 0x20000
    buffer_load_dwordx4 v[156:159], v4, s[24:27], 0 offen
    buffer_load_dword v160, v4, s[24:27], 0 offen offset:16
    buffer_load_dwordx4 v[36:39], v3, s[28:31], 0 offen offset:0 nt
    buffer_load_dwordx4 v[40:43], v3, s[28:31], 0 offen offset:128 nt
    buffer_load_dwordx4 v[44:47], v3, s[28:31], 0 offen offset:256 nt
    s_mov_b32 s56, 12288
    buffer_load_dwordx4 v[48:51], v3, s[28:31], s56 offen offset:0 nt
    buffer_load_dwordx4 v[52:55], v3, s[28:31], s56 offen offset:128 nt
    buffer_load_dwordx4 v[56:59], v3, s[28:31], s56 offen offset:256 nt
    s_mov_b32 s56, 24576
    buffer_load_dwordx4 v[60:63], v3, s[28:31], s56 offen offset:0 nt
    buffer_load_dwordx4 v[64:67], v3, s[28:31], s56 offen offset:128 nt
    buffer_load_dwordx4 v[68:71], v3, s[28:31], s56 offen offset:256 nt
    s_mov_b32 s56, 36864
    buffer_load_dwordx4 v[72:75], v3, s[28:31], s56 offen offset:0 nt
    buffer_load_dwordx4 v[76:79], v3, s[28:31], s56 offen offset:128 nt
    buffer_load_dwordx4 v[80:83], v3, s[28:31], s56 offen offset:256 nt
    s_mov_b32 s56, 49152
    buffer_load_dwordx4 v[84:87], v3, s[28:31], s56 offen offset:0 nt
    buffer_load_dwordx4 v[88:91], v3, s[28:31], s56 offen offset:128 nt
    buffer_load_dwordx4 v[92:95], v3, s[28:31], s56 offen offset:256 nt
    s_mov_b32 s56, 61440
    buffer_load_dwordx4 v[96:99], v3, s[28:31], s56 offen offset:0 nt
    buffer_load_dwordx4 v[100:103], v3, s[28:31], s56 offen offset:128 nt
    buffer_load_dwordx4 v[104:107], v3, s[28:31], s56 offen offset:256 nt
    s_mov_b32 s56, 73728
    buffer_load_dwordx4 v[108:111], v3, s[28:31], s56 offen offset:0 nt
    buffer_load_dwordx4 v[112:115], v3, s[28:31], s56 offen offset:128 nt
    buffer_load_dwordx4 v[116:119], v3, s[28:31], s56 offen offset:256 nt
    s_mov_b32 s56, 86016
    buffer_load_dwordx4 v[120:123], v3, s[28:31], s56 offen offset:0 nt
    buffer_load_dwordx4 v[124:127], v3, s[28:31], s56 offen offset:128 nt
    buffer_load_dwordx4 v[128:131], v3, s[28:31], s56 offen offset:256 nt
    s_mov_b32 s56, 98304
    buffer_load_dwordx4 v[132:135], v3, s[28:31], s56 offen offset:0 nt
    buffer_load_dwordx4 v[136:139], v3, s[28:31], s56 offen offset:128 nt
    buffer_load_dwordx4 v[140:143], v3, s[28:31], s56 offen offset:256 nt
    s_mov_b32 s56, 110592
    buffer_load_dwordx4 v[144:147], v3, s[28:31], s56 offen offset:0 nt
    buffer_load_dwordx4 v[148:151], v3, s[28:31], s56 offen offset:128 nt
    buffer_load_dwordx4 v[152:155], v3, s[28:31], s56 offen offset:256 nt
    v_mov_b32 v28, 0
    v_lshlrev_b32 v29, 2, v1
    ds_write_b32 v29, v28 offset:15360
    ds_write_b32 v29, v28 offset:12288
L_notsvc:
    s_add_u32 s32, s6, s58
    s_addc_u32 s33, s7, 0
    s_and_b32 s33, s33, 0xffff
    s_sub_u32 s34, 3145728, s59
    s_mov_b32 s35, 0x20000
    s_add_u32 s36, s8, s58
    s_addc_u32 s37, s9, 0
    s_and_b32 s37, s37, 0xffff
    s_sub_u32 s38, 3145728, s59
    s_mov_b32 s39, 0x20000
    v_and_b32 v28, 1, v10
    v_lshlrev_b32 v28, 4, v28
    v_mov_b32 v29, 0xffff
    v_lshlrev_b32 v28, v28, v29
    v_lshrrev_b32 v29, 1, v10
    v_cmp_eq_u32 s[62:63], 0, v29
    v_cmp_eq_u32 s[92:93], 1, v29
    v_cmp_eq_u32 s[94:95], 2, v29
    v_cmp_eq_u32 s[84:85], 3, v29
    s_nop 0
    v_cndmask_b32 v5, 0, v28, s[62:63]
    v_cndmask_b32 v6, 0, v28, s[92:93]
    v_cndmask_b32 v7, 0, v28, s[94:95]
    v_cndmask_b32 v8, 0, v28, s[84:85]
    s_mov_b32 s44, s18
    s_and_b32 s45, s19, 0xffff
    s_mov_b32 s46, 2621440
    s_mov_b32 s47, 0x20000
    s_add_u32 s92, s18, 1310720
    s_addc_u32 s93, s19, 0
    v_mov_b32 v16, 0
    v_mov_b32 v17, 0
    v_mov_b32 v18, 0
    v_mov_b32 v19, 0
    v_mov_b32 v20, 0
    v_mov_b32 v21, 0
    v_mov_b32 v22, 0
    v_mov_b32 v23, 0
    v_mov_b32 v24, 0
    v_mov_b32 v25, 0
    v_mov_b32 v26, 0
    v_mov_b32 v27, 0
    v_lshrrev_b32 v28, 5, v1
    v_mul_u32_u24 v28, 768, v28
    v_lshl_add_u32 v28, v10, 5, v28
    v_bfe_u32 v29, v1, 4, 1
    v_lshl_add_u32 v28, v29, 4, v28
    s_mul_i32 s56, s22, 1536
    v_add_u32 v33, s56, v28
    s_mov_b32 s82, 0x00ff00ff
    s_mov_b32 s83, 0xff00ff00
    s_waitcnt lgkmcnt(0)
    s_barrier
    s_load_dword s52, s[92:93], 0
    s_cmp_lg_u32 s22, 0
    s_cbranch_scc1 L_fill
    s_lshl_b32 s56, s20, 3
    s_add_u32 s56, s56, s21
    s_lshl_b32 s56, s56, 11
    s_add_u32 s53, s56, 0
    s_mov_b32 s58, 0x01000100
    s_mov_b32 s59, 0x03020302
    s_waitcnt vmcnt(27)
    v_perm_b32 v28, v156, v156, s58
    v_and_b32 v12, v28, v5
    v_and_b32 v13, v28, v6
    v_and_b32 v14, v28, v7
    v_and_b32 v15, v28, v8
    s_waitcnt vmcnt(27)
    s_nop 0
    v_mfma_f32_16x16x32_bf16 v[16:19], v[12:15], v[36:39], v[16:19]
    v_mfma_f32_16x16x32_bf16 v[20:23], v[12:15], v[40:43], v[20:23]
    v_mfma_f32_16x16x32_bf16 v[24:27], v[12:15], v[44:47], v[24:27]
    v_perm_b32 v28, v156, v156, s59
    v_and_b32 v12, v28, v5
    v_and_b32 v13, v28, v6
    v_and_b32 v14, v28, v7
    v_and_b32 v15, v28, v8
    s_waitcnt vmcnt(24)
    s_nop 0
    v_mfma_f32_16x16x32_bf16 v[16:19], v[12:15], v[48:51], v[16:19]
    v_mfma_f32_16x16x32_bf16 v[20:23], v[12:15], v[52:55], v[20:23]
    v_mfma_f32_16x16x32_bf16 v[24:27], v[12:15], v[56:59], v[24:27]
    v_perm_b32 v28, v157, v157, s58
    v_and_b32 v12, v28, v5
    v_and_b32 v13, v28, v6
    v_and_b32 v14, v28, v7
    v_and_b32 v15, v28, v8
    s_waitcnt vmcnt(21)
    s_nop 0
    v_mfma_f32_16x16x32_bf16 v[16:19], v[12:15], v[60:63], v[16:19]
    v_mfma_f32_16x16x32_bf16 v[20:23], v[12:15], v[64:67], v[20:23]
    v_mfma_f32_16x16x32_bf16 v[24:27], v[12:15], v[68:71], v[24:27]
    v_perm_b32 v28, v157, v157, s59
    v_and_b32 v12, v28, v5
    v_and_b32 v13, v28, v6
    v_and_b32 v14, v28, v7
    v_and_b32 v15, v28, v8
    s_waitcnt vmcnt(18)
    s_nop 0
    v_mfma_f32_16x16x32_bf16 v[16:19], v[12:15], v[72:75], v[16:19]
    v_mfma_f32_16x16x32_bf16 v[20:23], v[12:15], v[76:79], v[20:23]
    v_mfma_f32_16x16x32_bf16 v[24:27], v[12:15], v[80:83], v[24:27]
    v_perm_b32 v28, v158, v158, s58
    v_and_b32 v12, v28, v5
    v_and_b32 v13, v28, v6
    v_and_b32 v14, v28, v7
    v_and_b32 v15, v28, v8
    s_waitcnt vmcnt(15)
    s_nop 0
    v_mfma_f32_16x16x32_bf16 v[16:19], v[12:15], v[84:87], v[16:19]
    v_mfma_f32_16x16x32_bf16 v[20:23], v[12:15], v[88:91], v[20:23]
    v_mfma_f32_16x16x32_bf16 v[24:27], v[12:15], v[92:95], v[24:27]
    v_perm_b32 v28, v158, v158, s59
    v_and_b32 v12, v28, v5
    v_and_b32 v13, v28, v6
    v_and_b32 v14, v28, v7
    v_and_b32 v15, v28, v8
    s_waitcnt vmcnt(12)
    s_nop 0
    v_mfma_f32_16x16x32_bf16 v[16:19], v[12:15], v[96:99], v[16:19]
    v_mfma_f32_16x16x32_bf16 v[20:23], v[12:15], v[100:103], v[20:23]
    v_mfma_f32_16x16x32_bf16 v[24:27], v[12:15], v[104:107], v[24:27]
    v_perm_b32 v28, v159, v159, s58
    v_and_b32 v12, v28, v5
    v_and_b32 v13, v28, v6
    v_and_b32 v14, v28, v7
    v_and_b32 v15, v28, v8
    s_waitcnt vmcnt(9)
    s_nop 0
    v_mfma_f32_16x16x32_bf16 v[16:19], v[12:15], v[108:111], v[16:19]
    v_mfma_f32_16x16x32_bf16 v[20:23], v[12:15], v[112:115], v[20:23]
    v_mfma_f32_16x16x32_bf16 v[24:27], v[12:15], v[116:119], v[24:27]
    v_perm_b32 v28, v159, v159, s59
    v_and_b32 v12, v28, v5
    v_and_b32 v13, v28, v6
    v_and_b32 v14, v28, v7
    v_and_b32 v15, v28, v8
    s_waitcnt vmcnt(6)
    s_nop 0
    v_mfma_f32_16x16x32_bf16 v[16:19], v[12:15], v[120:123], v[16:19]
    v_mfma_f32_16x16x32_bf16 v[20:23], v[12:15], v[124:127], v[20:23]
    v_mfma_f32_16x16x32_bf16 v[24:27], v[12:15], v[128:131], v[24:27]
    v_perm_b32 v28, v160, v160, s58
    v_and_b32 v12, v28, v5
    v_and_b32 v13, v28, v6
    v_and_b32 v14, v28, v7
    v_and_b32 v15, v28, v8
    s_waitcnt vmcnt(3)
    s_nop 0
    v_mfma_f32_16x16x32_bf16 v[16:19], v[12:15], v[132:135], v[16:19]
    v_mfma_f32_16x16x32_bf16 v[20:23], v[12:15], v[136:139], v[20:23]
    v_mfma_f32_16x16x32_bf16 v[24:27], v[12:15], v[140:143], v[24:27]
    v_perm_b32 v28, v160, v160, s59
    v_and_b32 v12, v28, v5
    v_and_b32 v13, v28, v6
    v_and_b32 v14, v28, v7
    v_and_b32 v15, v28, v8
    s_waitcnt vmcnt(0)
    s_nop 0
    v_mfma_f32_16x16x32_bf16 v[16:19], v[12:15], v[144:147], v[16:19]
    v_mfma_f32_16x16x32_bf16 v[20:23], v[12:15], v[148:151], v[20:23]
    v_mfma_f32_16x16x32_bf16 v[24:27], v[12:15], v[152:155], v[24:27]
    v_lshlrev_b32 v28, 4, v1
    v_lshlrev_b32 v4, 3, v1
    s_lshl_b32 s56, s20, 14
    s_add_u32 s58, s56, 0
    s_mov_b32 s62, -1
    s_mov_b32 s63, 0x1ffff
    s_getreg_b32 s88, hwreg(HW_REG_XCC_ID, 0, 4)
    v_cmp_eq_u32 vcc, 48, v1
    s_mov_b64 exec, s[82:83]
    ds_write_b128 v33, v[16:19] offset:0
    ds_write_b128 v33, v[20:23] offset:256
    ds_write_b128 v33, v[24:27] offset:512
    s_mov_b64 exec, -1
    s_waitcnt lgkmcnt(0)
    s_add_u32 s60, s52, 1
    s_xor_b32 s61, s60, 0x9e3779b9
    s_mov_b64 exec, s[62:63]
    ds_read_b128 v[64:67], v28 offset:0
    ds_read_b128 v[68:71], v28 offset:768
    v_mov_b32 v14, s60
    v_mov_b32 v15, s61
    v_mov_b32 v18, s60
    v_mov_b32 v19, s61
    v_mov_b32 v29, s88
    s_waitcnt lgkmcnt(0)
    v_add_f32 v12, v64, v68
    v_add_f32 v13, v65, v69
    v_add_f32 v16, v66, v70
    v_add_f32 v17, v67, v71
    v_cndmask_b32 v12, v12, v29, vcc
    buffer_store_dwordx4 v[12:15], v28, s[44:47], s53 offen
    buffer_store_dwordx4 v[16:19], v28, s[44:47], s53 offen offset:1024
    s_add_u32 s59, s53, 2097152
    buffer_store_dwordx4 v[12:15], v28, s[44:47], s59 offen sc1
    buffer_store_dwordx4 v[16:19], v28, s[44:47], s59 offen offset:1024 sc1
    s_mov_b32 s57, 0
    s_mov_b32 s55, 0
L_pollq:
    s_and_b32 s56, s57, 3
    s_cmp_eq_u32 s56, 3
    s_cselect_b32 s59, 2097152, 0
    s_add_u32 s59, s59, s58
    s_bitcmp1_b32 s55, 0
    s_cbranch_scc1 L_pq_skip0
    s_add_u32 s56, s59, 0
    buffer_load_dwordx4 v[64:67], v28, s[44:47], s56 offen sc1
    buffer_load_dwordx4 v[68:71], v28, s[44:47], s56 offen offset:1024 sc1
L_pq_skip0:
    s_bitcmp1_b32 s55, 1
    s_cbranch_scc1 L_pq_skip1
    s_add_u32 s56, s59, 2048
    buffer_load_dwordx4 v[72:75], v28, s[44:47], s56 offen sc1
    buffer_load_dwordx4 v[76:79], v28, s[44:47], s56 offen offset:1024 sc1
L_pq_skip1:
    s_bitcmp1_b32 s55, 2
    s_cbranch_scc1 L_pq_skip2
    s_add_u32 s56, s59, 4096
    buffer_load_dwordx4 v[80:83], v28, s[44:47], s56 offen sc1
    buffer_load_dwordx4 v[84:87], v28, s[44:47], s56 offen offset:1024 sc1
L_pq_skip2:
    s_bitcmp1_b32 s55, 3
    s_cbranch_scc1 L_pq_skip3
    s_add_u32 s56, s59, 6144
    buffer_load_dwordx4 v[88:91], v28, s[44:47], s56 offen sc1
    buffer_load_dwordx4 v[92:95], v28, s[44:47], s56 offen offset:1024 sc1
L_pq_skip3:
    s_bitcmp1_b32 s55, 4
    s_cbranch_scc1 L_pq_skip4
    s_add_u32 s56, s59, 8192
    buffer_load_dwordx4 v[96:99], v28, s[44:47], s56 offen sc1
    buffer_load_dwordx4 v[100:103], v28, s[44:47], s56 offen offset:1024 sc1
L_pq_skip4:
    s_bitcmp1_b32 s55, 5
    s_cbranch_scc1 L_pq_skip5
    s_add_u32 s56, s59, 10240
    buffer_load_dwordx4 v[104:107], v28, s[44:47], s56 offen sc1
    buffer_load_dwordx4 v[108:111], v28, s[44:47], s56 offen offset:1024 sc1
L_pq_skip5:
    s_bitcmp1_b32 s55, 6
    s_cbranch_scc1 L_pq_skip6
    s_add_u32 s56, s59, 12288
    buffer_load_dwordx4 v[112:115], v28, s[44:47], s56 offen sc1
    buffer_load_dwordx4 v[116:119], v28, s[44:47], s56 offen offset:1024 sc1
L_pq_skip6:
    s_bitcmp1_b32 s55, 7
    s_cbranch_scc1 L_pq_skip7
    s_add_u32 s56, s59, 14336
    buffer_load_dwordx4 v[120:123], v28, s[44:47], s56 offen sc1
    buffer_load_dwordx4 v[124:127], v28, s[44:47], s56 offen offset:1024 sc1
L_pq_skip7:
    s_waitcnt vmcnt(0)
    v_cmp_eq_u64 vcc, s[60:61], v[66:67]
    v_cmp_eq_u64 s[94:95], s[60:61], v[70:71]
    s_and_b64 vcc, vcc, s[94:95]
    s_cmp_eq_u64 vcc, s[62:63]
    s_cselect_b32 s56, 1, 0
    s_or_b32 s55, s55, s56
    v_cmp_eq_u64 vcc, s[60:61], v[74:75]
    v_cmp_eq_u64 s[94:95], s[60:61], v[78:79]
    s_and_b64 vcc, vcc, s[94:95]
    s_cmp_eq_u64 vcc, s[62:63]
    s_cselect_b32 s56, 2, 0
    s_or_b32 s55, s55, s56
    v_cmp_eq_u64 vcc, s[60:61], v[82:83]
    v_cmp_eq_u64 s[94:95], s[60:61], v[86:87]
    s_and_b64 vcc, vcc, s[94:95]
    s_cmp_eq_u64 vcc, s[62:63]
    s_cselect_b32 s56, 4, 0
    s_or_b32 s55, s55, s56
    v_cmp_eq_u64 vcc, s[60:61], v[90:91]
    v_cmp_eq_u64 s[94:95], s[60:61], v[94:95]
    s_and_b64 vcc, vcc, s[94:95]
    s_cmp_eq_u64 vcc, s[62:63]
    s_cselect_b32 s56, 8, 0
    s_or_b32 s55, s55, s56
    v_cmp_eq_u64 vcc, s[60:61], v[98:99]
    v_cmp_eq_u64 s[94:95], s[60:61], v[102:103]
    s_and_b64 vcc, vcc, s[94:95]
    s_cmp_eq_u64 vcc, s[62:63]
    s_cselect_b32 s56, 16, 0
    s_or_b32 s55, s55, s56
    v_cmp_eq_u64 vcc, s[60:61], v[106:107]
    v_cmp_eq_u64 s[94:95], s[60:61], v[110:111]
    s_and_b64 vcc, vcc, s[94:95]
    s_cmp_eq_u64 vcc, s[62:63]
    s_cselect_b32 s56, 32, 0
    s_or_b32 s55, s55, s56
    v_cmp_eq_u64 vcc, s[60:61], v[114:115]
    v_cmp_eq_u64 s[94:95], s[60:61], v[118:119]
    s_and_b64 vcc, vcc, s[94:95]
    s_cmp_eq_u64 vcc, s[62:63]
    s_cselect_b32 s56, 64, 0
    s_or_b32 s55, s55, s56
    v_cmp_eq_u64 vcc, s[60:61], v[122:123]
    v_cmp_eq_u64 s[94:95], s[60:61], v[126:127]
    s_and_b64 vcc, vcc, s[94:95]
    s_cmp_eq_u64 vcc, s[62:63]
    s_cselect_b32 s56, 128, 0
    s_or_b32 s55, s55, s56
    s_cmp_eq_u32 s55, 0xff
    s_cbranch_scc1 L_pollq_ok
    s_add_u32 s57, s57, 1
    s_cmp_gt_u32 s57, 200000
    s_cbranch_scc0 L_pollq
L_pollq_ok:
    v_xor_b32 v29, s88, v64
    v_xor_b32 v30, s88, v72
    v_or_b32 v29, v29, v30
    v_xor_b32 v30, s88, v80
    v_or_b32 v29, v29, v30
    v_xor_b32 v30, s88, v88
    v_or_b32 v29, v29, v30
    v_xor_b32 v30, s88, v96
    v_or_b32 v29, v29, v30
    v_xor_b32 v30, s88, v104
    v_or_b32 v29, v29, v30
    v_xor_b32 v30, s88, v112
    v_or_b32 v29, v29, v30
    v_xor_b32 v30, s88, v120
    v_or_b32 v29, v29, v30
    s_nop 0
    v_readlane_b32 s89, v29, 48
    s_mov_b32 s62, -1
    s_mov_b32 s63, 0xffff
    s_mov_b64 exec, s[62:63]
    s_cmp_eq_u32 s89, 0
    s_cselect_b32 s89, 3, 1
    v_add_f32 v64, v64, v96
    v_add_f32 v72, v72, v104
    v_add_f32 v80, v80, v112
    v_add_f32 v88, v88, v120
    v_add_f32 v65, v65, v97
    v_add_f32 v73, v73, v105
    v_add_f32 v81, v81, v113
    v_add_f32 v89, v89, v121
    v_add_f32 v68, v68, v100
    v_add_f32 v76, v76, v108
    v_add_f32 v84, v84, v116
    v_add_f32 v92, v92, v124
    v_add_f32 v69, v69, v101
    v_add_f32 v77, v77, v109
    v_add_f32 v85, v85, v117
    v_add_f32 v93, v93, v125
    v_add_f32 v64, v64, v72
    v_add_f32 v80, v80, v88
    v_add_f32 v65, v65, v73
    v_add_f32 v81, v81, v89
    v_add_f32 v68, v68, v76
    v_add_f32 v84, v84, v92
    v_add_f32 v69, v69, v77
    v_add_f32 v85, v85, v93
    v_add_f32 v64, v64, v80
    v_add_f32 v65, v65, v81
    v_add_f32 v68, v68, v84
    v_add_f32 v69, v69, v85
    v_cvt_pk_bf16_f32 v12, v64, v65
    v_cvt_pk_bf16_f32 v13, v68, v69
    ds_write_b64 v4, v[12:13] offset:12416
    v_mov_b32 v30, s89
    v_mov_b32 v29, 0
    s_waitcnt lgkmcnt(0)
    s_mov_b64 exec, 1
    ds_write_b32 v29, v30 offset:15360
    s_mov_b64 exec, -1
    v_mov_b32 v16, 0
    v_mov_b32 v17, 0
    v_mov_b32 v18, 0
    v_mov_b32 v19, 0
    v_mov_b32 v20, 0
    v_mov_b32 v21, 0
    v_mov_b32 v22, 0
    v_mov_b32 v23, 0
    v_mov_b32 v24, 0
    v_mov_b32 v25, 0
    v_mov_b32 v26, 0
    v_mov_b32 v27, 0
    s_setprio 0
L_fill:
    buffer_load_dwordx4 v[64:67], v2, s[32:35], 0 offen offset:0 nt
    buffer_load_dwordx4 v[68:71], v2, s[32:35], 0 offen offset:128 nt
    buffer_load_dwordx4 v[72:75], v2, s[32:35], 0 offen offset:256 nt
    s_waitcnt vmcnt(6)
    s_mov_b32 s56, 196608
    buffer_load_dwordx4 v[76:79], v2, s[32:35], s56 offen offset:0 nt
    buffer_load_dwordx4 v[80:83], v2, s[32:35], s56 offen offset:128 nt
    buffer_load_dwordx4 v[84:87], v2, s[32:35], s56 offen offset:256 nt
    s_waitcnt vmcnt(6)
    s_mov_b32 s56, 393216
    buffer_load_dwordx4 v[88:91], v2, s[32:35], s56 offen offset:0 nt
    buffer_load_dwordx4 v[92:95], v2, s[32:35], s56 offen offset:128 nt
    buffer_load_dwordx4 v[96:99], v2, s[32:35], s56 offen offset:256 nt
    s_waitcnt vmcnt(6)
    s_mov_b32 s56, 589824
    buffer_load_dwordx4 v[100:103], v2, s[32:35], s56 offen offset:0 nt
    buffer_load_dwordx4 v[104:107], v2, s[32:35], s56 offen offset:128 nt
    buffer_load_dwordx4 v[108:111], v2, s[32:35], s56 offen offset:256 nt
    s_waitcnt vmcnt(6)
    s_mov_b32 s56, 786432
    buffer_load_dwordx4 v[112:115], v2, s[32:35], s56 offen offset:0 nt
    buffer_load_dwordx4 v[116:119], v2, s[32:35], s56 offen offset:128 nt
    buffer_load_dwordx4 v[120:123], v2, s[32:35], s56 offen offset:256 nt
    s_waitcnt vmcnt(6)
    s_mov_b32 s56, 983040
    buffer_load_dwordx4 v[124:127], v2, s[32:35], s56 offen offset:0 nt
    buffer_load_dwordx4 v[128:131], v2, s[32:35], s56 offen offset:128 nt
    buffer_load_dwordx4 v[132:135], v2, s[32:35], s56 offen offset:256 nt
    s_waitcnt vmcnt(6)
    s_mov_b32 s56, 1179648
    buffer_load_dwordx4 v[136:139], v2, s[32:35], s56 offen offset:0 nt
    buffer_load_dwordx4 v[140:143], v2, s[32:35], s56 offen offset:128 nt
    buffer_load_dwordx4 v[144:147], v2, s[32:35], s56 offen offset:256 nt
    s_waitcnt vmcnt(6)
    s_mov_b32 s56, 1376256
    buffer_load_dwordx4 v[148:151], v2, s[32:35], s56 offen offset:0 nt
    buffer_load_dwordx4 v[152:155], v2, s[32:35], s56 offen offset:128 nt
    buffer_load_dwordx4 v[156:159], v2, s[32:35], s56 offen offset:256 nt
    s_waitcnt vmcnt(6)
    s_mov_b32 s56, 1572864
    buffer_load_dwordx4 v[160:163], v2, s[32:35], s56 offen offset:0 nt
    buffer_load_dwordx4 v[164:167], v2, s[32:35], s56 offen offset:128 nt
    buffer_load_dwordx4 v[168:171], v2, s[32:35], s56 offen offset:256 nt
    s_waitcnt vmcnt(6)
    s_mov_b32 s56, 1769472
    buffer_load_dwordx4 v[172:175], v2, s[32:35], s56 offen offset:0 nt
    buffer_load_dwordx4 v[176:179], v2, s[32:35], s56 offen offset:128 nt
    buffer_load_dwordx4 v[180:183], v2, s[32:35], s56 offen offset:256 nt
    s_waitcnt vmcnt(6)
    s_mov_b32 s56, 1966080
    buffer_load_dwordx4 v[184:187], v2, s[32:35], s56 offen offset:0 nt
    buffer_load_dwordx4 v[188:191], v2, s[32:35], s56 offen offset:128 nt
    buffer_load_dwordx4 v[192:195], v2, s[32:35], s56 offen offset:256 nt
    s_waitcnt vmcnt(6)
    s_mov_b32 s56, 2162688
    buffer_load_dwordx4 v[196:199], v2, s[32:35], s56 offen offset:0 nt
    buffer_load_dwordx4 v[200:203], v2, s[32:35], s56 offen offset:128 nt
    buffer_load_dwordx4 v[204:207], v2, s[32:35], s56 offen offset:256 nt
    s_mul_i32 s56, s20, 245760
    s_mul_i32 s57, s21, 160
    s_add_u32 s56, s56, s57
    s_add_u32 s40, s12, s56
    s_addc_u32 s41, s13, 0
    s_and_b32 s41, s41, 0xffff
    s_sub_u32 s42, 245760, s57
    s_mov_b32 s43, 0x20000
    s_mov_b32 s48, s14
    s_and_b32 s49, s15, 0xffff
    s_mov_b32 s50, 1280
    s_mov_b32 s51, 0x20000
    v_lshrrev_b32 v28, 4, v1
    v_and_b32 v30, 15, v1
    v_mul_u32_u24 v29, 7680, v28
    v_lshl_add_u32 v29, v30, 4, v29
    s_mul_i32 s56, s22, 30720
    v_add_u32 v29, s56, v29
    v_mov_b32 v31, 0x7fffffff
    v_cmp_gt_u32 vcc, 10, v30
    v_min_u32 v32, 11, v30
    v_mul_u32_u24 v34, 3072, v28
    v_cndmask_b32 v35, v31, v29, vcc
    v_lshl_add_u32 v34, v32, 3, v34
    s_mul_i32 s56, s22, 96
    v_add_u32 v34, s56, v34
    v_lshlrev_b32 v221, 5, v30
    v_lshl_add_u32 v221, v28, 4, v221
    s_mul_i32 s56, s22, 320
    v_add_u32 v221, s56, v221
    v_bfe_u32 v29, v1, 1, 3
    v_lshlrev_b32 v29, 11, v29
    s_lshl_b32 s56, s22, 8
    v_add_u32 v29, s56, v29
    v_and_b32 v30, 1, v1
    v_lshl_add_u32 v32, v28, 1, v30
    v_add_u32 v28, 8, v28
    v_cmp_eq_u32 vcc, 1, v30
    v_mov_b32 v30, 12
    v_lshl_add_u32 v218, v32, 4, v29
    v_cndmask_b32 v28, v28, v30, vcc
    v_lshl_add_u32 v219, v28, 4, v29
    v_and_b32 v30, 15, v1
    v_mul_u32_u24 v28, 11, v30
    v_lshrrev_b32 v28, 5, v28
    v_mul_u32_u24 v29, 3, v28
    v_sub_u32 v29, v30, v29
    v_lshrrev_b32 v32, 1, v29
    v_lshl_add_u32 v32, v28, 1, v32
    v_add_u32 v28, 8, v28
    v_cmp_eq_u32 vcc, 1, v29
    v_cmp_eq_u32 s[62:63], 12, v30
    v_mov_b32 v29, 12
    v_cndmask_b32 v32, v32, v28, vcc
    v_cndmask_b32 v32, v32, v29, s[62:63]
    v_lshlrev_b32 v237, 4, v32
    v_lshlrev_b32 v220, 4, v1
    v_lshlrev_b32 v222, 3, v1
    v_lshlrev_b32 v236, 2, v1
    v_lshrrev_b32 v29, 2, v1
    v_lshlrev_b32 v29, 11, v29
    v_and_b32 v30, 3, v1
    v_lshl_add_u32 v29, v30, 4, v29
    v_cmp_gt_u32 vcc, 40, v1
    v_and_b32 v30, 8, v1
    v_cmp_eq_u32 s[62:63], 0, v30
    v_cndmask_b32 v223, v31, v29, vcc
    s_lshl_b32 s56, s20, 3
    s_add_u32 s56, s56, s21
    v_cndmask_b32 v224, 0, v5, s[62:63]
    v_cndmask_b32 v225, 0, v6, s[62:63]
    v_cndmask_b32 v226, 0, v7, s[62:63]
    v_cndmask_b32 v227, 0, v8, s[62:63]
    s_lshl_b32 s56, s56, 3
    s_add_u32 s56, s56, s22
    s_lshl_b32 s56, s56, 8
    s_add_u32 s80, s56, 524288
    s_lshl_b32 s56, s20, 14
    s_add_u32 s81, s56, 524288
    s_mul_i32 s56, s21, 20480
    s_add_u32 s56, s56, 1048576
    s_lshl_b32 s57, s20, 6
    s_add_u32 s86, s56, s57
    s_lshl_b32 s57, s20, 11
    s_add_u32 s87, s56, s57
    s_mul_i32 s56, s21, 160
    s_lshl_b32 s57, s20, 4
    s_add_u32 s90, s56, s57
    s_mov_b64 s[84:85], 0x1000
    s_and_b32 s56, s2, 7
    s_lshl_b32 s92, 1, s56
    s_lshl_b32 s94, 1, s21
    s_mov_b32 s95, 0
    s_mov_b32 s55, 0
    s_waitcnt lgkmcnt(0)
    s_add_u32 s60, s52, 1
    s_xor_b32 s61, s60, 0x9e3779b9
    v_mov_b32 v230, s60
    v_mov_b32 v231, s61
    v_mov_b32 v234, s60
    v_mov_b32 v235, s61
    v_mov_b32 v28, 0
    s_mov_b32 s58, 0
L_waitq:
    ds_read_b32 v30, v28 offset:15360
    s_waitcnt lgkmcnt(0)
    v_cmp_ne_u32 vcc, 0, v30
    s_cbranch_vccnz L_waitq_ok
    s_add_u32 s58, s58, 1
    s_cmp_gt_u32 s58, 800000
    s_cbranch_scc1 L_waitq_ok
    s_sleep 1
    s_branch L_waitq
L_waitq_ok:
    v_readfirstlane_b32 s89, v30
    v_lshlrev_b32 v28, 4, v10
    ds_read_b128 v[36:39], v28 offset:12416
    ds_read_b128 v[40:43], v28 offset:12544
    ds_read_b128 v[44:47], v28 offset:12672
    s_waitcnt lgkmcnt(0)
    v_mov_b32 v48, 0
    s_waitcnt vmcnt(33)
    v_dot2c_f32_bf16 v48, v64, v36
    v_dot2c_f32_bf16 v48, v65, v37
    v_dot2c_f32_bf16 v48, v66, v38
    v_dot2c_f32_bf16 v48, v67, v39
    v_dot2c_f32_bf16 v48, v68, v40
    v_dot2c_f32_bf16 v48, v69, v41
    v_dot2c_f32_bf16 v48, v70, v42
    v_dot2c_f32_bf16 v48, v71, v43
    v_dot2c_f32_bf16 v48, v72, v44
    v_dot2c_f32_bf16 v48, v73, v45
    v_dot2c_f32_bf16 v48, v74, v46
    v_dot2c_f32_bf16 v48, v75, v47
    s_mov_b32 s56, 2359296
    buffer_load_dwordx4 v[64:67], v2, s[32:35], s56 offen offset:0 nt
    buffer_load_dwordx4 v[68:71], v2, s[32:35], s56 offen offset:128 nt
    buffer_load_dwordx4 v[72:75], v2, s[32:35], s56 offen offset:256 nt
    v_mov_b32 v49, 0
    s_waitcnt vmcnt(33)
    v_dot2c_f32_bf16 v49, v76, v36
    v_dot2c_f32_bf16 v49, v77, v37
    v_dot2c_f32_bf16 v49, v78, v38
    v_dot2c_f32_bf16 v49, v79, v39
    v_dot2c_f32_bf16 v49, v80, v40
    v_dot2c_f32_bf16 v49, v81, v41
    v_dot2c_f32_bf16 v49, v82, v42
    v_dot2c_f32_bf16 v49, v83, v43
    v_dot2c_f32_bf16 v49, v84, v44
    v_dot2c_f32_bf16 v49, v85, v45
    v_dot2c_f32_bf16 v49, v86, v46
    v_dot2c_f32_bf16 v49, v87, v47
    s_mov_b32 s56, 2555904
    buffer_load_dwordx4 v[76:79], v2, s[32:35], s56 offen offset:0 nt
    buffer_load_dwordx4 v[80:83], v2, s[32:35], s56 offen offset:128 nt
    buffer_load_dwordx4 v[84:87], v2, s[32:35], s56 offen offset:256 nt
    v_mov_b32 v50, 0
    s_waitcnt vmcnt(33)
    v_dot2c_f32_bf16 v50, v88, v36
    v_dot2c_f32_bf16 v50, v89, v37
    v_dot2c_f32_bf16 v50, v90, v38
    v_dot2c_f32_bf16 v50, v91, v39
    v_dot2c_f32_bf16 v50, v92, v40
    v_dot2c_f32_bf16 v50, v93, v41
    v_dot2c_f32_bf16 v50, v94, v42
    v_dot2c_f32_bf16 v50, v95, v43
    v_dot2c_f32_bf16 v50, v96, v44
    v_dot2c_f32_bf16 v50, v97, v45
    v_dot2c_f32_bf16 v50, v98, v46
    v_dot2c_f32_bf16 v50, v99, v47
    s_mov_b32 s56, 2752512
    buffer_load_dwordx4 v[88:91], v2, s[32:35], s56 offen offset:0 nt
    buffer_load_dwordx4 v[92:95], v2, s[32:35], s56 offen offset:128 nt
    buffer_load_dwordx4 v[96:99], v2, s[32:35], s56 offen offset:256 nt
    v_mov_b32 v51, 0
    s_waitcnt vmcnt(33)
    v_dot2c_f32_bf16 v51, v100, v36
    v_dot2c_f32_bf16 v51, v101, v37
    v_dot2c_f32_bf16 v51, v102, v38
    v_dot2c_f32_bf16 v51, v103, v39
    v_dot2c_f32_bf16 v51, v104, v40
    v_dot2c_f32_bf16 v51, v105, v41
    v_dot2c_f32_bf16 v51, v106, v42
    v_dot2c_f32_bf16 v51, v107, v43
    v_dot2c_f32_bf16 v51, v108, v44
    v_dot2c_f32_bf16 v51, v109, v45
    v_dot2c_f32_bf16 v51, v110, v46
    v_dot2c_f32_bf16 v51, v111, v47
    v_mov_b32 v52, 0
    s_waitcnt vmcnt(30)
    v_dot2c_f32_bf16 v52, v112, v36
    v_dot2c_f32_bf16 v52, v113, v37
    v_dot2c_f32_bf16 v52, v114, v38
    v_dot2c_f32_bf16 v52, v115, v39
    v_dot2c_f32_bf16 v52, v116, v40
    v_dot2c_f32_bf16 v52, v117, v41
    v_dot2c_f32_bf16 v52, v118, v42
    v_dot2c_f32_bf16 v52, v119, v43
    v_dot2c_f32_bf16 v52, v120, v44
    v_dot2c_f32_bf16 v52, v121, v45
    v_dot2c_f32_bf16 v52, v122, v46
    v_dot2c_f32_bf16 v52, v123, v47
    v_mov_b32 v53, 0
    s_waitcnt vmcnt(27)
    v_dot2c_f32_bf16 v53, v124, v36
    v_dot2c_f32_bf16 v53, v125, v37
    v_dot2c_f32_bf16 v53, v126, v38
    v_dot2c_f32_bf16 v53, v127, v39
    v_dot2c_f32_bf16 v53, v128, v40
    v_dot2c_f32_bf16 v53, v129, v41
    v_dot2c_f32_bf16 v53, v130, v42
    v_dot2c_f32_bf16 v53, v131, v43
    v_dot2c_f32_bf16 v53, v132, v44
    v_dot2c_f32_bf16 v53, v133, v45
    v_dot2c_f32_bf16 v53, v134, v46
    v_dot2c_f32_bf16 v53, v135, v47
    v_mov_b32 v54, 0
    s_waitcnt vmcnt(24)
    v_dot2c_f32_bf16 v54, v136, v36
    v_dot2c_f32_bf16 v54, v137, v37
    v_dot2c_f32_bf16 v54, v138, v38
    v_dot2c_f32_bf16 v54, v139, v39
    v_dot2c_f32_bf16 v54, v140, v40
    v_dot2c_f32_bf16 v54, v141, v41
    v_dot2c_f32_bf16 v54, v142, v42
    v_dot2c_f32_bf16 v54, v143, v43
    v_dot2c_f32_bf16 v54, v144, v44
    v_dot2c_f32_bf16 v54, v145, v45
    v_dot2c_f32_bf16 v54, v146, v46
    v_dot2c_f32_bf16 v54, v147, v47
    v_mov_b32 v55, 0
    s_waitcnt vmcnt(21)
    v_dot2c_f32_bf16 v55, v148, v36
    v_dot2c_f32_bf16 v55, v149, v37
    v_dot2c_f32_bf16 v55, v150, v38
    v_dot2c_f32_bf16 v55, v151, v39
    v_dot2c_f32_bf16 v55, v152, v40
    v_dot2c_f32_bf16 v55, v153, v41
    v_dot2c_f32_bf16 v55, v154, v42
    v_dot2c_f32_bf16 v55, v155, v43
    v_dot2c_f32_bf16 v55, v156, v44
    v_dot2c_f32_bf16 v55, v157, v45
    v_dot2c_f32_bf16 v55, v158, v46
    v_dot2c_f32_bf16 v55, v159, v47
    v_mov_b32 v56, 0
    s_waitcnt vmcnt(18)
    v_dot2c_f32_bf16 v56, v160, v36
    v_dot2c_f32_bf16 v56, v161, v37
    v_dot2c_f32_bf16 v56, v162, v38
    v_dot2c_f32_bf16 v56, v163, v39
    v_dot2c_f32_bf16 v56, v164, v40
    v_dot2c_f32_bf16 v56, v165, v41
    v_dot2c_f32_bf16 v56, v166, v42
    v_dot2c_f32_bf16 v56, v167, v43
    v_dot2c_f32_bf16 v56, v168, v44
    v_dot2c_f32_bf16 v56, v169, v45
    v_dot2c_f32_bf16 v56, v170, v46
    v_dot2c_f32_bf16 v56, v171, v47
    v_mov_b32 v57, 0
    s_waitcnt vmcnt(15)
    v_dot2c_f32_bf16 v57, v172, v36
    v_dot2c_f32_bf16 v57, v173, v37
    v_dot2c_f32_bf16 v57, v174, v38
    v_dot2c_f32_bf16 v57, v175, v39
    v_dot2c_f32_bf16 v57, v176, v40
    v_dot2c_f32_bf16 v57, v177, v41
    v_dot2c_f32_bf16 v57, v178, v42
    v_dot2c_f32_bf16 v57, v179, v43
    v_dot2c_f32_bf16 v57, v180, v44
    v_dot2c_f32_bf16 v57, v181, v45
    v_dot2c_f32_bf16 v57, v182, v46
    v_dot2c_f32_bf16 v57, v183, v47
    v_mov_b32 v58, 0
    s_waitcnt vmcnt(12)
    v_dot2c_f32_bf16 v58, v184, v36
    v_dot2c_f32_bf16 v58, v185, v37
    v_dot2c_f32_bf16 v58, v186, v38
    v_dot2c_f32_bf16 v58, v187, v39
    v_dot2c_f32_bf16 v58, v188, v40
    v_dot2c_f32_bf16 v58, v189, v41
    v_dot2c_f32_bf16 v58, v190, v42
    v_dot2c_f32_bf16 v58, v191, v43
    v_dot2c_f32_bf16 v58, v192, v44
    v_dot2c_f32_bf16 v58, v193, v45
    v_dot2c_f32_bf16 v58, v194, v46
    v_dot2c_f32_bf16 v58, v195, v47
    v_mov_b32 v59, 0
    s_waitcnt vmcnt(9)
    v_dot2c_f32_bf16 v59, v196, v36
    v_dot2c_f32_bf16 v59, v197, v37
    v_dot2c_f32_bf16 v59, v198, v38
    v_dot2c_f32_bf16 v59, v199, v39
    v_dot2c_f32_bf16 v59, v200, v40
    v_dot2c_f32_bf16 v59, v201, v41
    v_dot2c_f32_bf16 v59, v202, v42
    v_dot2c_f32_bf16 v59, v203, v43
    v_dot2c_f32_bf16 v59, v204, v44
    v_dot2c_f32_bf16 v59, v205, v45
    v_dot2c_f32_bf16 v59, v206, v46
    v_dot2c_f32_bf16 v59, v207, v47
    v_mov_b32 v60, 0
    s_waitcnt vmcnt(6)
    s_mov_b32 s56, 2949120
    buffer_load_dwordx4 v[100:103], v2, s[32:35], s56 offen offset:0 nt
    buffer_load_dwordx4 v[104:107], v2, s[32:35], s56 offen offset:128 nt
    buffer_load_dwordx4 v[108:111], v2, s[32:35], s56 offen offset:256 nt
    v_dot2c_f32_bf16 v60, v64, v36
    v_dot2c_f32_bf16 v60, v65, v37
    v_dot2c_f32_bf16 v60, v66, v38
    v_dot2c_f32_bf16 v60, v67, v39
    v_dot2c_f32_bf16 v60, v68, v40
    v_dot2c_f32_bf16 v60, v69, v41
    v_dot2c_f32_bf16 v60, v70, v42
    v_dot2c_f32_bf16 v60, v71, v43
    v_dot2c_f32_bf16 v60, v72, v44
    v_dot2c_f32_bf16 v60, v73, v45
    v_dot2c_f32_bf16 v60, v74, v46
    v_dot2c_f32_bf16 v60, v75, v47
    v_mov_b32 v61, 0
    s_waitcnt vmcnt(6)
    buffer_load_dwordx4 v[64:67], v2, s[36:39], 0 offen offset:0 nt
    buffer_load_dwordx4 v[68:71], v2, s[36:39], 0 offen offset:128 nt
    buffer_load_dwordx4 v[72:75], v2, s[36:39], 0 offen offset:256 nt
    v_dot2c_f32_bf16 v61, v76, v36
    v_dot2c_f32_bf16 v61, v77, v37
    v_dot2c_f32_bf16 v61, v78, v38
    v_dot2c_f32_bf16 v61, v79, v39
    v_dot2c_f32_bf16 v61, v80, v40
    v_dot2c_f32_bf16 v61, v81, v41
    v_dot2c_f32_bf16 v61, v82, v42
    v_dot2c_f32_bf16 v61, v83, v43
    v_dot2c_f32_bf16 v61, v84, v44
    v_dot2c_f32_bf16 v61, v85, v45
    v_dot2c_f32_bf16 v61, v86, v46
    v_dot2c_f32_bf16 v61, v87, v47
    v_mov_b32 v62, 0
    s_waitcnt vmcnt(6)
    s_mov_b32 s56, 196608
    buffer_load_dwordx4 v[76:79], v2, s[36:39], s56 offen offset:0 nt
    buffer_load_dwordx4 v[80:83], v2, s[36:39], s56 offen offset:128 nt
    buffer_load_dwordx4 v[84:87], v2, s[36:39], s56 offen offset:256 nt
    v_dot2c_f32_bf16 v62, v88, v36
    v_dot2c_f32_bf16 v62, v89, v37
    v_dot2c_f32_bf16 v62, v90, v38
    v_dot2c_f32_bf16 v62, v91, v39
    v_dot2c_f32_bf16 v62, v92, v40
    v_dot2c_f32_bf16 v62, v93, v41
    v_dot2c_f32_bf16 v62, v94, v42
    v_dot2c_f32_bf16 v62, v95, v43
    v_dot2c_f32_bf16 v62, v96, v44
    v_dot2c_f32_bf16 v62, v97, v45
    v_dot2c_f32_bf16 v62, v98, v46
    v_dot2c_f32_bf16 v62, v99, v47
    v_mov_b32 v63, 0
    s_waitcnt vmcnt(6)
    s_cmp_lg_u32 s22, 3
    s_cbranch_scc1 L_nomark0
    s_lshl_b32 s56, s20, 11
    s_add_u32 s56, s56, 65536
    s_mov_b32 s57, s21
    s_lshl_b32 s57, s57, 4
    s_add_u32 s56, s56, s57
    s_add_u32 s56, s56, 1376256
    v_mov_b32 v28, 0
    s_mov_b64 exec, 1
    s_bitcmp1_b32 s89, 1
    s_cbranch_scc1 L_mkl0
    buffer_store_dwordx4 v[228:231], v28, s[44:47], s56 offen sc1
    s_branch L_mkd0
L_mkl0:
    buffer_store_dwordx4 v[228:231], v28, s[44:47], s56 offen
L_mkd0:
    s_mov_b64 exec, -1
L_nomark0:
    s_cmp_lg_u32 s22, 7
    s_cbranch_scc1 L_nomark2
    s_lshr_b32 s56, s2, 3
    s_lshl_b32 s56, s56, 11
    s_and_b32 s57, s2, 7
    s_lshl_b32 s57, s57, 4
    s_add_u32 s56, s56, s57
    s_add_u32 s56, s56, 1376512
    v_mov_b32 v28, 0
    s_mov_b64 exec, 1
    buffer_store_dwordx4 v[228:231], v28, s[44:47], s56 offen sc1
    s_mov_b64 exec, -1
L_nomark2:
    s_mov_b32 s56, 393216
    buffer_load_dwordx4 v[88:91], v2, s[36:39], s56 offen offset:0 nt
    buffer_load_dwordx4 v[92:95], v2, s[36:39], s56 offen offset:128 nt
    buffer_load_dwordx4 v[96:99], v2, s[36:39], s56 offen offset:256 nt
    s_mov_b32 s56, 589824
    buffer_load_dwordx4 v[112:115], v2, s[36:39], s56 offen offset:0 nt
    buffer_load_dwordx4 v[116:119], v2, s[36:39], s56 offen offset:128 nt
    buffer_load_dwordx4 v[120:123], v2, s[36:39], s56 offen offset:256 nt
    v_dot2c_f32_bf16 v63, v100, v36
    v_dot2c_f32_bf16 v63, v101, v37
    v_dot2c_f32_bf16 v63, v102, v38
    v_dot2c_f32_bf16 v63, v103, v39
    v_dot2c_f32_bf16 v63, v104, v40
    v_dot2c_f32_bf16 v63, v105, v41
    v_dot2c_f32_bf16 v63, v106, v42
    v_dot2c_f32_bf16 v63, v107, v43
    v_dot2c_f32_bf16 v63, v108, v44
    v_dot2c_f32_bf16 v63, v109, v45
    v_dot2c_f32_bf16 v63, v110, v46
    v_dot2c_f32_bf16 v63, v111, v47
    s_lshr_b32 s56, s22, 2
    s_cmp_lg_u32 s56, 0
    s_cbranch_scc1 L_gpre0
    s_lshl_b32 s93, s20, 11
    s_add_u32 s93, s93, 1441792
    s_mov_b64 exec, 0xff
    buffer_load_dwordx4 v[252:255], v220, s[44:47], s93 offen sc1
    s_mov_b64 exec, -1
L_gpre0:
    s_lshr_b32 s56, s22, 2
    s_cmp_lg_u32 s56, 1
    s_cbranch_scc1 L_gpre2
    s_lshr_b32 s91, s2, 3
    s_lshl_b32 s91, s91, 11
    s_add_u32 s91, s91, 1376512
    s_mov_b64 exec, 0xff
    buffer_load_dwordx4 v[240:243], v220, s[44:47], s91 offen sc1
    s_mov_b64 exec, -1
L_gpre2:
    s_nop 1
    v_add_f32_dpp v48, v48, v48 quad_perm:[1,0,3,2] row_mask:0xf bank_mask:0xf
    v_add_f32_dpp v49, v49, v49 quad_perm:[1,0,3,2] row_mask:0xf bank_mask:0xf
    v_add_f32_dpp v50, v50, v50 quad_perm:[1,0,3,2] row_mask:0xf bank_mask:0xf
    v_add_f32_dpp v51, v51, v51 quad_perm:[1,0,3,2] row_mask:0xf bank_mask:0xf
    v_add_f32_dpp v52, v52, v52 quad_perm:[1,0,3,2] row_mask:0xf bank_mask:0xf
    v_add_f32_dpp v53, v53, v53 quad_perm:[1,0,3,2] row_mask:0xf bank_mask:0xf
    v_add_f32_dpp v54, v54, v54 quad_perm:[1,0,3,2] row_mask:0xf bank_mask:0xf
    v_add_f32_dpp v55, v55, v55 quad_perm:[1,0,3,2] row_mask:0xf bank_mask:0xf
    v_add_f32_dpp v56, v56, v56 quad_perm:[1,0,3,2] row_mask:0xf bank_mask:0xf
    v_add_f32_dpp v57, v57, v57 quad_perm:[1,0,3,2] row_mask:0xf bank_mask:0xf
    v_add_f32_dpp v58, v58, v58 quad_perm:[1,0,3,2] row_mask:0xf bank_mask:0xf
    v_add_f32_dpp v59, v59, v59 quad_perm:[1,0,3,2] row_mask:0xf bank_mask:0xf
    v_add_f32_dpp v60, v60, v60 quad_perm:[1,0,3,2] row_mask:0xf bank_mask:0xf
    v_add_f32_dpp v61, v61, v61 quad_perm:[1,0,3,2] row_mask:0xf bank_mask:0xf
    v_add_f32_dpp v62, v62, v62 quad_perm:[1,0,3,2] row_mask:0xf bank_mask:0xf
    v_add_f32_dpp v63, v63, v63 quad_perm:[1,0,3,2] row_mask:0xf bank_mask:0xf
    v_add_f32_dpp v48, v48, v48 quad_perm:[2,3,0,1] row_mask:0xf bank_mask:0xf
    v_add_f32_dpp v49, v49, v49 quad_perm:[2,3,0,1] row_mask:0xf bank_mask:0xf
    v_add_f32_dpp v50, v50, v50 quad_perm:[2,3,0,1] row_mask:0xf bank_mask:0xf
    v_add_f32_dpp v51, v51, v51 quad_perm:[2,3,0,1] row_mask:0xf bank_mask:0xf
    v_add_f32_dpp v52, v52, v52 quad_perm:[2,3,0,1] row_mask:0xf bank_mask:0xf
    v_add_f32_dpp v53, v53, v53 quad_perm:[2,3,0,1] row_mask:0xf bank_mask:0xf
    v_add_f32_dpp v54, v54, v54 quad_perm:[2,3,0,1] row_mask:0xf bank_mask:0xf
    v_add_f32_dpp v55, v55, v55 quad_perm:[2,3,0,1] row_mask:0xf bank_mask:0xf
    v_add_f32_dpp v56, v56, v56 quad_perm:[2,3,0,1] row_mask:0xf bank_mask:0xf
    v_add_f32_dpp v57, v57, v57 quad_perm:[2,3,0,1] row_mask:0xf bank_mask:0xf
    v_add_f32_dpp v58, v58, v58 quad_perm:[2,3,0,1] row_mask:0xf bank_mask:0xf
    v_add_f32_dpp v59, v59, v59 quad_perm:[2,3,0,1] row_mask:0xf bank_mask:0xf
    v_add_f32_dpp v60, v60, v60 quad_perm:[2,3,0,1] row_mask:0xf bank_mask:0xf
    v_add_f32_dpp v61, v61, v61 quad_perm:[2,3,0,1] row_mask:0xf bank_mask:0xf
    v_add_f32_dpp v62, v62, v62 quad_perm:[2,3,0,1] row_mask:0xf bank_mask:0xf
    v_add_f32_dpp v63, v63, v63 quad_perm:[2,3,0,1] row_mask:0xf bank_mask:0xf
    v_add_f32_dpp v48, v48, v48 row_half_mirror row_mask:0xf bank_mask:0xf
    v_add_f32_dpp v49, v49, v49 row_half_mirror row_mask:0xf bank_mask:0xf
    v_add_f32_dpp v50, v50, v50 row_half_mirror row_mask:0xf bank_mask:0xf
    v_add_f32_dpp v51, v51, v51 row_half_mirror row_mask:0xf bank_mask:0xf
    v_add_f32_dpp v52, v52, v52 row_half_mirror row_mask:0xf bank_mask:0xf
    v_add_f32_dpp v53, v53, v53 row_half_mirror row_mask:0xf bank_mask:0xf
    v_add_f32_dpp v54, v54, v54 row_half_mirror row_mask:0xf bank_mask:0xf
    v_add_f32_dpp v55, v55, v55 row_half_mirror row_mask:0xf bank_mask:0xf
    v_add_f32_dpp v56, v56, v56 row_half_mirror row_mask:0xf bank_mask:0xf
    v_add_f32_dpp v57, v57, v57 row_half_mirror row_mask:0xf bank_mask:0xf
    v_add_f32_dpp v58, v58, v58 row_half_mirror row_mask:0xf bank_mask:0xf
    v_add_f32_dpp v59, v59, v59 row_half_mirror row_mask:0xf bank_mask:0xf
    v_add_f32_dpp v60, v60, v60 row_half_mirror row_mask:0xf bank_mask:0xf
    v_add_f32_dpp v61, v61, v61 row_half_mirror row_mask:0xf bank_mask:0xf
    v_add_f32_dpp v62, v62, v62 row_half_mirror row_mask:0xf bank_mask:0xf
    v_add_f32_dpp v63, v63, v63 row_half_mirror row_mask:0xf bank_mask:0xf
    s_mov_b32 s56, 0x3d93cd3a
    s_mov_b32 s57, 0xffff0000
    v_cvt_pk_bf16_f32 v28, v48, v49
    v_lshlrev_b32 v48, 16, v28
    v_and_b32 v49, s57, v28
    v_mul_f32 v48, s56, v48
    v_mul_f32 v49, s56, v49
    v_cvt_pk_bf16_f32 v28, v48, v49
    v_lshlrev_b32 v48, 16, v28
    v_and_b32 v49, s57, v28
    v_cvt_pk_bf16_f32 v28, v50, v51
    v_lshlrev_b32 v50, 16, v28
    v_and_b32 v51, s57, v28
    v_mul_f32 v50, s56, v50
    v_mul_f32 v51, s56, v51
    v_cvt_pk_bf16_f32 v28, v50, v51
    v_lshlrev_b32 v50, 16, v28
    v_and_b32 v51, s57, v28
    v_cvt_pk_bf16_f32 v28, v52, v53
    v_lshlrev_b32 v52, 16, v28
    v_and_b32 v53, s57, v28
    v_mul_f32 v52, s56, v52
    v_mul_f32 v53, s56, v53
    v_cvt_pk_bf16_f32 v28, v52, v53
    v_lshlrev_b32 v52, 16, v28
    v_and_b32 v53, s57, v28
    v_cvt_pk_bf16_f32 v28, v54, v55
    v_lshlrev_b32 v54, 16, v28
    v_and_b32 v55, s57, v28
    v_mul_f32 v54, s56, v54
    v_mul_f32 v55, s56, v55
    v_cvt_pk_bf16_f32 v28, v54, v55
    v_lshlrev_b32 v54, 16, v28
    v_and_b32 v55, s57, v28
    v_cvt_pk_bf16_f32 v28, v56, v57
    v_lshlrev_b32 v56, 16, v28
    v_and_b32 v57, s57, v28
    v_mul_f32 v56, s56, v56
    v_mul_f32 v57, s56, v57
    v_cvt_pk_bf16_f32 v28, v56, v57
    v_lshlrev_b32 v56, 16, v28
    v_and_b32 v57, s57, v28
    v_cvt_pk_bf16_f32 v28, v58, v59
    v_lshlrev_b32 v58, 16, v28
    v_and_b32 v59, s57, v28
    v_mul_f32 v58, s56, v58
    v_mul_f32 v59, s56, v59
    v_cvt_pk_bf16_f32 v28, v58, v59
    v_lshlrev_b32 v58, 16, v28
    v_and_b32 v59, s57, v28
    v_cvt_pk_bf16_f32 v28, v60, v61
    v_lshlrev_b32 v60, 16, v28
    v_and_b32 v61, s57, v28
    v_mul_f32 v60, s56, v60
    v_mul_f32 v61, s56, v61
    v_cvt_pk_bf16_f32 v28, v60, v61
    v_lshlrev_b32 v60, 16, v28
    v_and_b32 v61, s57, v28
    v_cvt_pk_bf16_f32 v28, v62, v63
    v_lshlrev_b32 v62, 16, v28
    v_and_b32 v63, s57, v28
    v_mul_f32 v62, s56, v62
    v_mul_f32 v63, s56, v63
    v_cvt_pk_bf16_f32 v28, v62, v63
    v_lshlrev_b32 v62, 16, v28
    v_and_b32 v63, s57, v28
    v_max3_f32 v28, v48, v49, v50
    v_max3_f32 v28, v28, v51, v52
    v_max3_f32 v28, v28, v53, v54
    v_max3_f32 v28, v28, v55, v56
    v_max3_f32 v28, v28, v57, v58
    v_max3_f32 v28, v28, v59, v60
    v_max3_f32 v28, v28, v61, v62
    v_max_f32 v28, v28, v63
    s_nop 1
    v_max_f32_dpp v28, v28, v28 row_ror:8 row_mask:0xf bank_mask:0xf
    v_mov_b32 v29, v28
    s_nop 1
    v_permlane16_swap_b32 v29, v28
    s_nop 1
    v_max_f32 v28, v28, v29
    v_mov_b32 v29, v28
    s_nop 1
    v_permlane32_swap_b32 v29, v28
    s_nop 1
    v_max_f32 v28, v28, v29
    s_mov_b32 s56, 0x3fb8aa3b
    v_mul_f32 v31, s56, v28
    v_fma_f32 v48, v48, s56, -v31
    v_fma_f32 v49, v49, s56, -v31
    v_fma_f32 v50, v50, s56, -v31
    v_fma_f32 v51, v51, s56, -v31
    v_fma_f32 v52, v52, s56, -v31
    v_fma_f32 v53, v53, s56, -v31
    v_fma_f32 v54, v54, s56, -v31
    v_fma_f32 v55, v55, s56, -v31
    v_fma_f32 v56, v56, s56, -v31
    v_fma_f32 v57, v57, s56, -v31
    v_fma_f32 v58, v58, s56, -v31
    v_fma_f32 v59, v59, s56, -v31
    v_fma_f32 v60, v60, s56, -v31
    v_fma_f32 v61, v61, s56, -v31
    v_fma_f32 v62, v62, s56, -v31
    v_fma_f32 v63, v63, s56, -v31
    v_exp_f32 v48, v48
    v_exp_f32 v49, v49
    v_exp_f32 v50, v50
    v_exp_f32 v51, v51
    v_exp_f32 v52, v52
    v_exp_f32 v53, v53
    v_exp_f32 v54, v54
    v_exp_f32 v55, v55
    v_exp_f32 v56, v56
    v_exp_f32 v57, v57
    v_exp_f32 v58, v58
    v_exp_f32 v59, v59
    v_exp_f32 v60, v60
    v_exp_f32 v61, v61
    v_exp_f32 v62, v62
    v_exp_f32 v63, v63
    s_nop 0
    v_add_f32 v30, v48, v49
    v_add_f32 v30, v30, v50
    v_add_f32 v30, v30, v51
    v_add_f32 v30, v30, v52
    v_add_f32 v30, v30, v53
    v_add_f32 v30, v30, v54
    v_add_f32 v30, v30, v55
    v_add_f32 v30, v30, v56
    v_add_f32 v30, v30, v57
    v_add_f32 v30, v30, v58
    v_add_f32 v30, v30, v59
    v_add_f32 v30, v30, v60
    v_add_f32 v30, v30, v61
    v_add_f32 v30, v30, v62
    v_add_f32 v30, v30, v63
    s_nop 1
    v_add_f32_dpp v30, v30, v30 row_ror:8 row_mask:0xf bank_mask:0xf
    v_mov_b32 v29, v30
    s_nop 1
    v_permlane16_swap_b32 v29, v30
    s_nop 1
    v_add_f32 v30, v30, v29
    v_mov_b32 v29, v30
    s_nop 1
    v_permlane32_swap_b32 v29, v30
    s_nop 1
    v_add_f32 v30, v30, v29
    v_mov_b32 v28, 12288
    s_lshl_b32 s56, s22, 4
    v_add_u32 v28, s56, v28
    v_mov_b32 v12, v31
    v_mov_b32 v13, v30
    v_mov_b32 v14, 1
    v_mov_b32 v15, 0
    s_mov_b64 exec, 1
    ds_write_b128 v28, v[12:15]
    s_mov_b64 exec, -1
    v_cvt_pk_bf16_f32 v28, v48, v48
    v_and_b32 v12, v28, v5
    v_and_b32 v13, v28, v6
    v_and_b32 v14, v28, v7
    v_and_b32 v15, v28, v8
    s_waitcnt vmcnt(9)
    s_nop 0
    v_mfma_f32_16x16x32_bf16 v[16:19], v[12:15], v[64:67], v[16:19]
    v_mfma_f32_16x16x32_bf16 v[20:23], v[12:15], v[68:71], v[20:23]
    v_mfma_f32_16x16x32_bf16 v[24:27], v[12:15], v[72:75], v[24:27]
    v_cvt_pk_bf16_f32 v28, v49, v49
    v_and_b32 v12, v28, v5
    v_and_b32 v13, v28, v6
    v_and_b32 v14, v28, v7
    v_and_b32 v15, v28, v8
    s_waitcnt vmcnt(6)
    s_mov_b32 s56, 786432
    buffer_load_dwordx4 v[64:67], v2, s[36:39], s56 offen offset:0 nt
    buffer_load_dwordx4 v[68:71], v2, s[36:39], s56 offen offset:128 nt
    buffer_load_dwordx4 v[72:75], v2, s[36:39], s56 offen offset:256 nt
    s_nop 0
    v_mfma_f32_16x16x32_bf16 v[16:19], v[12:15], v[76:79], v[16:19]
    v_mfma_f32_16x16x32_bf16 v[20:23], v[12:15], v[80:83], v[20:23]
    v_mfma_f32_16x16x32_bf16 v[24:27], v[12:15], v[84:87], v[24:27]
    s_lshr_b32 s56, s22, 2
    s_cmp_lg_u32 s56, 0
    s_cbranch_scc1 L_gate0_ok
    s_mov_b32 s58, 0
    s_mov_b64 exec, 0xff
    s_waitcnt vmcnt(3)
L_gate0:
    v_cmp_eq_u64 vcc, s[60:61], v[254:255]
    s_or_b32 s56, vcc_lo, s94
    s_cmp_eq_u32 s56, 0xff
    s_cbranch_scc1 L_gate0_done
    s_add_u32 s58, s58, 1
    s_cmp_gt_u32 s58, 200000
    s_cbranch_scc1 L_gate0_done
    s_sleep 1
    buffer_load_dwordx4 v[252:255], v220, s[44:47], s93 offen sc1
    s_waitcnt vmcnt(0)
    s_branch L_gate0
L_gate0_done:
    s_mov_b64 exec, -1
L_gate0_ok:
    s_lshr_b32 s56, s22, 2
    s_cmp_lg_u32 s56, 1
    s_cbranch_scc1 L_gate2_ok
    s_mov_b32 s58, 0
    s_mov_b64 exec, 0xff
    s_waitcnt vmcnt(3)
L_gate2:
    v_cmp_eq_u64 vcc, s[60:61], v[242:243]
    s_or_b32 s56, vcc_lo, s92
    s_cmp_eq_u32 s56, 0xff
    s_cbranch_scc1 L_gate2_done
    s_add_u32 s58, s58, 1
    s_cmp_gt_u32 s58, 200000
    s_cbranch_scc1 L_gate2_done
    s_sleep 1
    buffer_load_dwordx4 v[240:243], v220, s[44:47], s91 offen sc1
    s_waitcnt vmcnt(0)
    s_branch L_gate2
L_gate2_done:
    s_mov_b64 exec, -1
L_gate2_ok:
    v_cvt_pk_bf16_f32 v28, v50, v50
    v_and_b32 v12, v28, v5
    v_and_b32 v13, v28, v6
    v_and_b32 v14, v28, v7
    v_and_b32 v15, v28, v8
    s_waitcnt vmcnt(6)
    s_mov_b32 s56, 983040
    buffer_load_dwordx4 v[76:79], v2, s[36:39], s56 offen offset:0 nt
    buffer_load_dwordx4 v[80:83], v2, s[36:39], s56 offen offset:128 nt
    buffer_load_dwordx4 v[84:87], v2, s[36:39], s56 offen offset:256 nt
    s_nop 0
    v_mfma_f32_16x16x32_bf16 v[16:19], v[12:15], v[88:91], v[16:19]
    v_mfma_f32_16x16x32_bf16 v[20:23], v[12:15], v[92:95], v[20:23]
    v_mfma_f32_16x16x32_bf16 v[24:27], v[12:15], v[96:99], v[24:27]
    v_cvt_pk_bf16_f32 v28, v51, v51
    v_and_b32 v12, v28, v5
    v_and_b32 v13, v28, v6
    v_and_b32 v14, v28, v7
    v_and_b32 v15, v28, v8
    s_waitcnt vmcnt(6)
    s_cmp_lg_u32 s22, 3
    s_cbranch_scc1 L_nomark1
    s_lshr_b32 s56, s2, 3
    s_lshl_b32 s56, s56, 11
    s_and_b32 s57, s2, 7
    s_lshl_b32 s57, s57, 4
    s_add_u32 s56, s56, s57
    s_add_u32 s56, s56, 1376384
    v_mov_b32 v28, 0
    s_mov_b64 exec, 1
    buffer_store_dwordx4 v[228:231], v28, s[44:47], s56 offen sc1
    s_mov_b64 exec, -1
L_nomark1:
    s_mov_b32 s56, 1179648
    buffer_load_dwordx4 v[88:91], v2, s[36:39], s56 offen offset:0 nt
    buffer_load_dwordx4 v[92:95], v2, s[36:39], s56 offen offset:128 nt
    buffer_load_dwordx4 v[96:99], v2, s[36:39], s56 offen offset:256 nt
    s_nop 0
    v_mfma_f32_16x16x32_bf16 v[16:19], v[12:15], v[112:115], v[16:19]
    v_mfma_f32_16x16x32_bf16 v[20:23], v[12:15], v[116:119], v[20:23]
    v_mfma_f32_16x16x32_bf16 v[24:27], v[12:15], v[120:123], v[24:27]
    s_lshr_b32 s56, s22, 2
    s_cmp_lg_u32 s56, 0
    s_cbranch_scc1 L_gpre1
    s_lshr_b32 s91, s2, 3
    s_lshl_b32 s91, s91, 11
    s_add_u32 s91, s91, 1376384
    s_mov_b64 exec, 0xff
    buffer_load_dwordx4 v[240:243], v220, s[44:47], s91 offen sc1
    s_mov_b64 exec, -1
L_gpre1:
    v_cvt_pk_bf16_f32 v28, v52, v52
    v_and_b32 v12, v28, v5
    v_and_b32 v13, v28, v6
    v_and_b32 v14, v28, v7
    v_and_b32 v15, v28, v8
    s_waitcnt vmcnt(6)
    s_mov_b32 s56, 1376256
    buffer_load_dwordx4 v[100:103], v2, s[36:39], s56 offen offset:0 nt
    buffer_load_dwordx4 v[104:107], v2, s[36:39], s56 offen offset:128 nt
    buffer_load_dwordx4 v[108:111], v2, s[36:39], s56 offen offset:256 nt
    s_nop 0
    v_mfma_f32_16x16x32_bf16 v[16:19], v[12:15], v[64:67], v[16:19]
    v_mfma_f32_16x16x32_bf16 v[20:23], v[12:15], v[68:71], v[20:23]
    v_mfma_f32_16x16x32_bf16 v[24:27], v[12:15], v[72:75], v[24:27]
    v_cvt_pk_bf16_f32 v28, v53, v53
    v_and_b32 v12, v28, v5
    v_and_b32 v13, v28, v6
    v_and_b32 v14, v28, v7
    v_and_b32 v15, v28, v8
    s_waitcnt vmcnt(6)
    s_mov_b32 s56, 1572864
    buffer_load_dwordx4 v[64:67], v2, s[36:39], s56 offen offset:0 nt
    buffer_load_dwordx4 v[68:71], v2, s[36:39], s56 offen offset:128 nt
    buffer_load_dwordx4 v[72:75], v2, s[36:39], s56 offen offset:256 nt
    s_nop 0
    v_mfma_f32_16x16x32_bf16 v[16:19], v[12:15], v[76:79], v[16:19]
    v_mfma_f32_16x16x32_bf16 v[20:23], v[12:15], v[80:83], v[20:23]
    v_mfma_f32_16x16x32_bf16 v[24:27], v[12:15], v[84:87], v[24:27]
    s_lshr_b32 s56, s22, 2
    s_cmp_lg_u32 s56, 0
    s_cbranch_scc1 L_gate1_ok
    s_mov_b32 s58, 0
    s_mov_b64 exec, 0xff
    s_waitcnt vmcnt(6)
L_gate1:
    v_cmp_eq_u64 vcc, s[60:61], v[242:243]
    s_or_b32 s56, vcc_lo, s92
    s_cmp_eq_u32 s56, 0xff
    s_cbranch_scc1 L_gate1_done
    s_add_u32 s58, s58, 1
    s_cmp_gt_u32 s58, 200000
    s_cbranch_scc1 L_gate1_done
    s_sleep 1
    buffer_load_dwordx4 v[240:243], v220, s[44:47], s91 offen sc1
    s_waitcnt vmcnt(0)
    s_branch L_gate1
L_gate1_done:
    s_mov_b64 exec, -1
L_gate1_ok:
    v_cvt_pk_bf16_f32 v28, v54, v54
    v_and_b32 v12, v28, v5
    v_and_b32 v13, v28, v6
    v_and_b32 v14, v28, v7
    v_and_b32 v15, v28, v8
    s_waitcnt vmcnt(6)
    s_cmp_lg_u32 s22, 7
    s_cbranch_scc1 L_nomark3
    s_lshl_b32 s56, s20, 11
    s_add_u32 s56, s56, 65536
    s_mov_b32 s57, s21
    s_lshl_b32 s57, s57, 4
    s_add_u32 s56, s56, s57
    s_add_u32 s56, s56, 1376640
    v_mov_b32 v28, 0
    s_mov_b64 exec, 1
    s_bitcmp1_b32 s89, 1
    s_cbranch_scc1 L_mkl3
    buffer_store_dwordx4 v[228:231], v28, s[44:47], s56 offen sc1
    s_branch L_mkd3
L_mkl3:
    buffer_store_dwordx4 v[228:231], v28, s[44:47], s56 offen
L_mkd3:
    s_mov_b64 exec, -1
L_nomark3:
    s_mov_b32 s56, 1769472
    buffer_load_dwordx4 v[76:79], v2, s[36:39], s56 offen offset:0 nt
    buffer_load_dwordx4 v[80:83], v2, s[36:39], s56 offen offset:128 nt
    buffer_load_dwordx4 v[84:87], v2, s[36:39], s56 offen offset:256 nt
    s_nop 0
    v_mfma_f32_16x16x32_bf16 v[16:19], v[12:15], v[88:91], v[16:19]
    v_mfma_f32_16x16x32_bf16 v[20:23], v[12:15], v[92:95], v[20:23]
    v_mfma_f32_16x16x32_bf16 v[24:27], v[12:15], v[96:99], v[24:27]
    s_lshr_b32 s56, s22, 2
    s_cmp_lg_u32 s56, 1
    s_cbranch_scc1 L_gpre3
    s_lshl_b32 s93, s20, 11
    s_add_u32 s93, s93, 1442176
    s_mov_b64 exec, 0xff
    buffer_load_dwordx4 v[252:255], v220, s[44:47], s93 offen sc1
    s_mov_b64 exec, -1
L_gpre3:
    v_cvt_pk_bf16_f32 v28, v55, v55
    v_and_b32 v12, v28, v5
    v_and_b32 v13, v28, v6
    v_and_b32 v14, v28, v7
    v_and_b32 v15, v28, v8
    s_waitcnt vmcnt(6)
    s_mov_b32 s56, 1966080
    buffer_load_dwordx4 v[88:91], v2, s[36:39], s56 offen offset:0 nt
    buffer_load_dwordx4 v[92:95], v2, s[36:39], s56 offen offset:128 nt
    buffer_load_dwordx4 v[96:99], v2, s[36:39], s56 offen offset:256 nt
    s_nop 0
    v_mfma_f32_16x16x32_bf16 v[16:19], v[12:15], v[100:103], v[16:19]
    v_mfma_f32_16x16x32_bf16 v[20:23], v[12:15], v[104:107], v[20:23]
    v_mfma_f32_16x16x32_bf16 v[24:27], v[12:15], v[108:111], v[24:27]
    v_cvt_pk_bf16_f32 v28, v56, v56
    v_and_b32 v12, v28, v5
    v_and_b32 v13, v28, v6
    v_and_b32 v14, v28, v7
    v_and_b32 v15, v28, v8
    s_waitcnt vmcnt(6)
    s_mov_b32 s56, 2162688
    buffer_load_dwordx4 v[100:103], v2, s[36:39], s56 offen offset:0 nt
    buffer_load_dwordx4 v[104:107], v2, s[36:39], s56 offen offset:128 nt
    buffer_load_dwordx4 v[108:111], v2, s[36:39], s56 offen offset:256 nt
    s_nop 0
    v_mfma_f32_16x16x32_bf16 v[16:19], v[12:15], v[64:67], v[16:19]
    v_mfma_f32_16x16x32_bf16 v[20:23], v[12:15], v[68:71], v[20:23]
    v_mfma_f32_16x16x32_bf16 v[24:27], v[12:15], v[72:75], v[24:27]
    s_lshr_b32 s56, s22, 2
    s_cmp_lg_u32 s56, 1
    s_cbranch_scc1 L_gate3_ok
    s_mov_b32 s58, 0
    s_mov_b64 exec, 0xff
    s_waitcnt vmcnt(6)
L_gate3:
    v_cmp_eq_u64 vcc, s[60:61], v[254:255]
    s_or_b32 s56, vcc_lo, s94
    s_cmp_eq_u32 s56, 0xff
    s_cbranch_scc1 L_gate3_done
    s_add_u32 s58, s58, 1
    s_cmp_gt_u32 s58, 200000
    s_cbranch_scc1 L_gate3_done
    s_sleep 1
    buffer_load_dwordx4 v[252:255], v220, s[44:47], s93 offen sc1
    s_waitcnt vmcnt(0)
    s_branch L_gate3
L_gate3_done:
    s_mov_b64 exec, -1
L_gate3_ok:
    v_cvt_pk_bf16_f32 v28, v57, v57
    v_and_b32 v12, v28, v5
    v_and_b32 v13, v28, v6
    v_and_b32 v14, v28, v7
    v_and_b32 v15, v28, v8
    s_waitcnt vmcnt(6)
    s_mov_b32 s56, 2359296
    buffer_load_dwordx4 v[64:67], v2, s[36:39], s56 offen offset:0 nt
    buffer_load_dwordx4 v[68:71], v2, s[36:39], s56 offen offset:128 nt
    buffer_load_dwordx4 v[72:75], v2, s[36:39], s56 offen offset:256 nt
    s_nop 0
    v_mfma_f32_16x16x32_bf16 v[16:19], v[12:15], v[76:79], v[16:19]
    v_mfma_f32_16x16x32_bf16 v[20:23], v[12:15], v[80:83], v[20:23]
    v_mfma_f32_16x16x32_bf16 v[24:27], v[12:15], v[84:87], v[24:27]
    v_cvt_pk_bf16_f32 v28, v58, v58
    v_and_b32 v12, v28, v5
    v_and_b32 v13, v28, v6
    v_and_b32 v14, v28, v7
    v_and_b32 v15, v28, v8
    s_waitcnt vmcnt(6)
    s_mov_b32 s56, 2555904
    buffer_load_dwordx4 v[76:79], v2, s[36:39], s56 offen offset:0 nt
    buffer_load_dwordx4 v[80:83], v2, s[36:39], s56 offen offset:128 nt
    buffer_load_dwordx4 v[84:87], v2, s[36:39], s56 offen offset:256 nt
    s_nop 0
    v_mfma_f32_16x16x32_bf16 v[16:19], v[12:15], v[88:91], v[16:19]
    v_mfma_f32_16x16x32_bf16 v[20:23], v[12:15], v[92:95], v[20:23]
    v_mfma_f32_16x16x32_bf16 v[24:27], v[12:15], v[96:99], v[24:27]
    v_cvt_pk_bf16_f32 v28, v59, v59
    v_and_b32 v12, v28, v5
    v_and_b32 v13, v28, v6
    v_and_b32 v14, v28, v7
    v_and_b32 v15, v28, v8
    s_waitcnt vmcnt(6)
    s_mov_b32 s56, 2752512
    buffer_load_dwordx4 v[88:91], v2, s[36:39], s56 offen offset:0 nt
    buffer_load_dwordx4 v[92:95], v2, s[36:39], s56 offen offset:128 nt
    buffer_load_dwordx4 v[96:99], v2, s[36:39], s56 offen offset:256 nt
    s_nop 0
    v_mfma_f32_16x16x32_bf16 v[16:19], v[12:15], v[100:103], v[16:19]
    v_mfma_f32_16x16x32_bf16 v[20:23], v[12:15], v[104:107], v[20:23]
    v_mfma_f32_16x16x32_bf16 v[24:27], v[12:15], v[108:111], v[24:27]
    v_cvt_pk_bf16_f32 v28, v60, v60
    v_and_b32 v12, v28, v5
    v_and_b32 v13, v28, v6
    v_and_b32 v14, v28, v7
    v_and_b32 v15, v28, v8
    s_waitcnt vmcnt(6)
    s_mov_b32 s56, 2949120
    buffer_load_dwordx4 v[100:103], v2, s[36:39], s56 offen offset:0 nt
    buffer_load_dwordx4 v[104:107], v2, s[36:39], s56 offen offset:128 nt
    buffer_load_dwordx4 v[108:111], v2, s[36:39], s56 offen offset:256 nt
    s_nop 0
    v_mfma_f32_16x16x32_bf16 v[16:19], v[12:15], v[64:67], v[16:19]
    v_mfma_f32_16x16x32_bf16 v[20:23], v[12:15], v[68:71], v[20:23]
    v_mfma_f32_16x16x32_bf16 v[24:27], v[12:15], v[72:75], v[24:27]
    v_cvt_pk_bf16_f32 v28, v61, v61
    v_and_b32 v12, v28, v5
    v_and_b32 v13, v28, v6
    v_and_b32 v14, v28, v7
    v_and_b32 v15, v28, v8
    s_waitcnt vmcnt(6)
    s_nop 0
    v_mfma_f32_16x16x32_bf16 v[16:19], v[12:15], v[76:79], v[16:19]
    v_mfma_f32_16x16x32_bf16 v[20:23], v[12:15], v[80:83], v[20:23]
    v_mfma_f32_16x16x32_bf16 v[24:27], v[12:15], v[84:87], v[24:27]
    s_cmp_lg_u32 s22, 7
    s_cbranch_scc1 L_wof
    v_mov_b32 v28, 0
    v_mov_b32 v29, 1
    s_mov_b64 exec, 1
    ds_write_b32 v28, v29 offset:15392
    s_mov_b64 exec, -1
L_wof:
    v_lshlrev_b32 v32, 4, v10
    s_mov_b32 s58, 0
L_waitml:
    ds_read_b128 v[208:211], v32 offset:12288
    s_waitcnt lgkmcnt(0)
    v_cmp_eq_u32 vcc, 1, v210
    s_cmp_eq_u64 vcc, -1
    s_cbranch_scc1 L_waitml_ok
    s_add_u32 s58, s58, 1
    s_cmp_gt_u32 s58, 800000
    s_cbranch_scc1 L_waitml_ok
    s_sleep 2
    s_branch L_waitml
L_waitml_ok:
    v_mov_b32 v216, v208
    s_nop 1
    v_max_f32_dpp v216, v216, v216 quad_perm:[1,0,3,2] row_mask:0xf bank_mask:0xf
    s_nop 1
    v_max_f32_dpp v216, v216, v216 quad_perm:[2,3,0,1] row_mask:0xf bank_mask:0xf
    s_nop 1
    v_max_f32_dpp v216, v216, v216 row_half_mirror row_mask:0xf bank_mask:0xf
    v_sub_f32 v212, v208, v216
    v_exp_f32 v212, v212
    s_nop 0
    v_mul_f32 v217, v212, v209
    v_readlane_b32 s54, v212, s22
    s_nop 1
    v_add_f32_dpp v217, v217, v217 quad_perm:[1,0,3,2] row_mask:0xf bank_mask:0xf
    s_nop 1
    v_add_f32_dpp v217, v217, v217 quad_perm:[2,3,0,1] row_mask:0xf bank_mask:0xf
    s_nop 1
    v_add_f32_dpp v217, v217, v217 row_half_mirror row_mask:0xf bank_mask:0xf
    v_mul_f32 v16, s54, v16
    v_mul_f32 v17, s54, v17
    v_mul_f32 v18, s54, v18
    v_mul_f32 v19, s54, v19
    v_mul_f32 v20, s54, v20
    v_mul_f32 v21, s54, v21
    v_mul_f32 v22, s54, v22
    v_mul_f32 v23, s54, v23
    v_mul_f32 v24, s54, v24
    v_mul_f32 v25, s54, v25
    v_mul_f32 v26, s54, v26
    v_mul_f32 v27, s54, v27
    v_mul_f32 v62, s54, v62
    v_mul_f32 v63, s54, v63
    v_cvt_pk_bf16_f32 v28, v62, v62
    v_and_b32 v12, v28, v5
    v_and_b32 v13, v28, v6
    v_and_b32 v14, v28, v7
    v_and_b32 v15, v28, v8
    s_waitcnt vmcnt(3)
    s_nop 0
    v_mfma_f32_16x16x32_bf16 v[16:19], v[12:15], v[88:91], v[16:19]
    v_mfma_f32_16x16x32_bf16 v[20:23], v[12:15], v[92:95], v[20:23]
    v_mfma_f32_16x16x32_bf16 v[24:27], v[12:15], v[96:99], v[24:27]
    v_cvt_pk_bf16_f32 v28, v63, v63
    v_and_b32 v12, v28, v5
    v_and_b32 v13, v28, v6
    v_and_b32 v14, v28, v7
    v_and_b32 v15, v28, v8
    s_waitcnt vmcnt(0)
    s_nop 0
    v_mfma_f32_16x16x32_bf16 v[16:19], v[12:15], v[100:103], v[16:19]
    v_mfma_f32_16x16x32_bf16 v[20:23], v[12:15], v[104:107], v[20:23]
    v_mfma_f32_16x16x32_bf16 v[24:27], v[12:15], v[108:111], v[24:27]
    s_cmp_ge_u32 s22, 4
    s_cbranch_scc1 L_wo_go
    v_mov_b32 v28, 0
    s_mov_b32 s58, 0
L_wo_wait:
    ds_read_b32 v29, v28 offset:15392
    s_waitcnt lgkmcnt(0)
    v_cmp_ne_u32 vcc, 0, v29
    s_cbranch_vccnz L_wo_go
    s_add_u32 s58, s58, 1
    s_cmp_gt_u32 s58, 800000
    s_cbranch_scc1 L_wo_go
    s_sleep 2
    s_branch L_wo_wait
L_wo_go:
    buffer_load_dwordx4 v[196:199], v35, s[40:43], 0 offen offset:0 nt
    buffer_load_dwordx4 v[200:203], v35, s[40:43], 0 offen offset:1280 nt
    buffer_load_dwordx4 v[204:207], v35, s[40:43], 0 offen offset:2560 nt
    buffer_load_dwordx4 v[184:187], v35, s[40:43], 0 offen offset:3840 nt
    s_mov_b32 s56, 5120
    buffer_load_dwordx4 v[188:191], v35, s[40:43], s56 offen nt
    s_mov_b32 s56, 6400
    buffer_load_dwordx4 v[192:195], v35, s[40:43], s56 offen nt
    s_nop 4
    s_mov_b64 exec, s[82:83]
    ds_write_b128 v33, v[16:19] offset:0
    ds_write_b128 v33, v[20:23] offset:256
    ds_write_b128 v33, v[24:27] offset:512
    s_mov_b64 exec, -1
    s_waitcnt lgkmcnt(0)
    s_barrier
    ds_read_b64 v[64:65], v34 offset:0
    ds_read_b64 v[66:67], v34 offset:768
    ds_read_b64 v[68:69], v34 offset:1536
    ds_read_b64 v[70:71], v34 offset:2304
    s_bitcmp1_b32 s89, 1
    s_waitcnt lgkmcnt(0)
    v_add_f32 v64, v64, v66
    v_add_f32 v65, v65, v67
    v_add_f32 v68, v68, v70
    v_add_f32 v69, v69, v71
    v_add_f32 v228, v64, v68
    v_add_f32 v229, v65, v69
    v_mov_b32 v28, v228
    v_mov_b32 v29, v229
    s_nop 0
    v_permlane16_swap_b32 v28, v228
    v_permlane16_swap_b32 v29, v229
    s_nop 0
    v_add_f32 v228, v228, v28
    v_add_f32 v229, v229, v29
    v_mov_b32 v28, v228
    v_mov_b32 v29, v229
    s_nop 0
    v_permlane32_swap_b32 v28, v228
    v_permlane32_swap_b32 v29, v229
    s_nop 0
    v_add_f32 v228, v228, v28
    v_add_f32 v229, v229, v29
    v_cndmask_b32 v228, v228, v216, s[84:85]
    v_cndmask_b32 v229, v229, v217, s[84:85]
    s_mov_b64 exec, 0x1fff
    s_cbranch_scc1 L_pub1_local
    buffer_store_dwordx4 v[228:231], v237, s[44:47], s80 offen sc1
    s_branch L_pub1_done
L_pub1_local:
    buffer_store_dwordx4 v[228:231], v237, s[44:47], s80 offen
L_pub1_done:
    s_mov_b64 exec, -1
    v_mov_b32 v16, 0
    v_mov_b32 v17, 0
    v_mov_b32 v18, 0
    v_mov_b32 v19, 0
    v_mov_b32 v20, 0
    v_mov_b32 v21, 0
    v_mov_b32 v22, 0
    v_mov_b32 v23, 0
    s_mov_b32 s58, 0
L_poll1:
    buffer_load_dwordx4 v[64:67], v218, s[44:47], s81 offen sc1
    buffer_load_dwordx4 v[68:71], v219, s[44:47], s81 offen sc1
    s_waitcnt vmcnt(0)
    v_cmp_eq_u64 vcc, s[60:61], v[66:67]
    v_cmp_eq_u64 s[62:63], s[60:61], v[70:71]
    s_and_b64 vcc, vcc, s[62:63]
    s_andn2_b64 exec, exec, vcc
    s_cbranch_execz L_poll1_ok
    s_add_u32 s58, s58, 1
    s_cmp_gt_u32 s58, 200000
    s_cbranch_scc0 L_poll1
L_poll1_ok:
    s_mov_b64 exec, -1
    v_mov_b32_dpp v29, v68 quad_perm:[1,1,3,3] row_mask:0xf bank_mask:0xf
    s_nop 1
    v_max_f32_dpp v32, v29, v29 quad_perm:[2,3,0,1] row_mask:0xf bank_mask:0xf
    s_nop 1
    v_max_f32_dpp v32, v32, v32 row_ror:4 row_mask:0xf bank_mask:0xf
    s_nop 1
    v_max_f32_dpp v32, v32, v32 row_ror:8 row_mask:0xf bank_mask:0xf
    v_sub_f32 v29, v29, v32
    v_exp_f32 v29, v29
    s_nop 0
    v_mul_f32 v69, v29, v69
    v_mul_f32 v64, v29, v64
    v_mul_f32 v65, v29, v65
    v_mul_f32 v68, v29, v68
    v_add_f32_dpp v69, v69, v69 quad_perm:[2,3,0,1] row_mask:0xf bank_mask:0xf
    v_add_f32_dpp v64, v64, v64 quad_perm:[2,3,0,1] row_mask:0xf bank_mask:0xf
    v_add_f32_dpp v65, v65, v65 quad_perm:[2,3,0,1] row_mask:0xf bank_mask:0xf
    v_add_f32_dpp v68, v68, v68 quad_perm:[2,3,0,1] row_mask:0xf bank_mask:0xf
    v_add_f32_dpp v69, v69, v69 row_ror:4 row_mask:0xf bank_mask:0xf
    v_add_f32_dpp v64, v64, v64 row_ror:4 row_mask:0xf bank_mask:0xf
    v_add_f32_dpp v65, v65, v65 row_ror:4 row_mask:0xf bank_mask:0xf
    v_add_f32_dpp v68, v68, v68 row_ror:4 row_mask:0xf bank_mask:0xf
    v_add_f32_dpp v69, v69, v69 row_ror:8 row_mask:0xf bank_mask:0xf
    v_add_f32_dpp v64, v64, v64 row_ror:8 row_mask:0xf bank_mask:0xf
    v_add_f32_dpp v65, v65, v65 row_ror:8 row_mask:0xf bank_mask:0xf
    v_add_f32_dpp v68, v68, v68 row_ror:8 row_mask:0xf bank_mask:0xf
    v_mov_b32_dpp v4, v69 quad_perm:[1,1,3,3] row_mask:0xf bank_mask:0xf
    v_mov_b32_dpp v72, v64 quad_perm:[0,0,2,2] row_mask:0xf bank_mask:0xf
    v_mov_b32_dpp v73, v65 quad_perm:[0,0,2,2] row_mask:0xf bank_mask:0xf
    v_rcp_f32 v4, v4
    v_mov_b32_dpp v74, v68 quad_perm:[0,0,2,2] row_mask:0xf bank_mask:0xf
    v_mov_b32_dpp v75, v69 quad_perm:[0,0,2,2] row_mask:0xf bank_mask:0xf
    v_mov_b32_dpp v76, v64 quad_perm:[1,1,3,3] row_mask:0xf bank_mask:0xf
    v_mov_b32_dpp v77, v65 quad_perm:[1,1,3,3] row_mask:0xf bank_mask:0xf
    v_mul_f32 v72, v4, v72
    v_mul_f32 v73, v4, v73
    v_mul_f32 v74, v4, v74
    v_mul_f32 v75, v4, v75
    v_mul_f32 v76, v4, v76
    v_mul_f32 v77, v4, v77
    v_cvt_pk_bf16_f32 v72, v72, v72
    v_cvt_pk_bf16_f32 v73, v73, v73
    v_cvt_pk_bf16_f32 v74, v74, v74
    v_cvt_pk_bf16_f32 v75, v75, v75
    v_cvt_pk_bf16_f32 v76, v76, v76
    v_cvt_pk_bf16_f32 v77, v77, v77
    v_and_b32 v36, v72, v224
    v_and_b32 v37, v72, v225
    v_and_b32 v38, v72, v226
    v_and_b32 v39, v72, v227
    v_and_b32 v40, v73, v224
    v_and_b32 v41, v73, v225
    v_and_b32 v42, v73, v226
    v_and_b32 v43, v73, v227
    v_mfma_f32_16x16x32_bf16 v[16:19], v[36:39], v[196:199], v[16:19]
    v_and_b32 v44, v74, v224
    v_and_b32 v45, v74, v225
    v_and_b32 v46, v74, v226
    v_and_b32 v47, v74, v227
    v_mfma_f32_16x16x32_bf16 v[20:23], v[40:43], v[200:203], v[20:23]
    v_and_b32 v48, v75, v224
    v_and_b32 v49, v75, v225
    v_and_b32 v50, v75, v226
    v_and_b32 v51, v75, v227
    v_mfma_f32_16x16x32_bf16 v[16:19], v[44:47], v[204:207], v[16:19]
    v_and_b32 v52, v76, v224
    v_and_b32 v53, v76, v225
    v_and_b32 v54, v76, v226
    v_and_b32 v55, v76, v227
    v_mfma_f32_16x16x32_bf16 v[20:23], v[48:51], v[184:187], v[20:23]
    v_and_b32 v56, v77, v224
    v_and_b32 v57, v77, v225
    v_and_b32 v58, v77, v226
    v_and_b32 v59, v77, v227
    v_mfma_f32_16x16x32_bf16 v[16:19], v[52:55], v[188:191], v[16:19]
    s_nop 1
    v_mfma_f32_16x16x32_bf16 v[20:23], v[56:59], v[192:195], v[20:23]
    s_nop 7
    v_add_f32 v16, v16, v20
    v_add_f32 v17, v17, v21
    v_add_f32 v18, v18, v22
    v_add_f32 v19, v19, v23
    s_mov_b64 exec, 0x03ff03ff
    ds_write_b128 v221, v[16:19] offset:12800
    s_mov_b64 exec, -1
    s_waitcnt lgkmcnt(0)
    s_barrier
    s_cmp_lg_u32 s22, 0
    s_cbranch_scc1 L_fin
    ds_read_b64 v[64:65], v222 offset:12800
    ds_read_b64 v[66:67], v222 offset:13120
    ds_read_b64 v[68:69], v222 offset:13440
    ds_read_b64 v[70:71], v222 offset:13760
    ds_read_b64 v[72:73], v222 offset:14080
    ds_read_b64 v[74:75], v222 offset:14400
    ds_read_b64 v[76:77], v222 offset:14720
    ds_read_b64 v[78:79], v222 offset:15040
    s_cmp_ge_u32 s20, 10
    s_waitcnt lgkmcnt(0)
    v_add_f32 v64, v64, v72
    v_add_f32 v65, v65, v73
    v_add_f32 v66, v66, v74
    v_add_f32 v67, v67, v75
    v_add_f32 v68, v68, v76
    v_add_f32 v69, v69, v77
    v_add_f32 v70, v70, v78
    v_add_f32 v71, v71, v79
    v_add_f32 v64, v64, v68
    v_add_f32 v65, v65, v69
    v_add_f32 v66, v66, v70
    v_add_f32 v67, v67, v71
    v_add_f32 v232, v64, v66
    v_add_f32 v233, v65, v67
    buffer_store_dwordx4 v[232:235], v223, s[44:47], s86 offen sc1
    s_cbranch_scc1 L_fin
L_p2start:
    s_mov_b32 s58, 0
L_poll2:
    buffer_load_dwordx4 v[88:91], v220, s[44:47], s87 offen sc1
    buffer_load_dwordx4 v[92:95], v220, s[44:47], s87 offen offset:1024 sc1
    s_waitcnt vmcnt(0)
    v_cmp_eq_u64 vcc, s[60:61], v[90:91]
    v_cmp_eq_u64 s[62:63], s[60:61], v[94:95]
    s_and_b64 vcc, vcc, s[62:63]
    s_andn2_b64 exec, exec, vcc
    s_cbranch_execz L_poll2_ok
    s_add_u32 s58, s58, 1
    s_cmp_gt_u32 s58, 200000
    s_cbranch_scc0 L_poll2
L_poll2_ok:
    s_mov_b64 exec, -1
    v_add_f32 v80, v88, v92
    v_add_f32 v81, v89, v93
    s_nop 0
    v_add_f32_dpp v80, v80, v80 row_ror:4 row_mask:0xf bank_mask:0xf
    v_add_f32_dpp v81, v81, v81 row_ror:4 row_mask:0xf bank_mask:0xf
    s_nop 0
    v_add_f32_dpp v80, v80, v80 row_ror:8 row_mask:0xf bank_mask:0xf
    v_add_f32_dpp v81, v81, v81 row_ror:8 row_mask:0xf bank_mask:0xf
    v_mov_b32 v28, v80
    v_mov_b32 v29, v81
    s_nop 0
    v_permlane16_swap_b32 v28, v80
    v_permlane16_swap_b32 v29, v81
    s_nop 0
    v_add_f32 v80, v80, v28
    v_add_f32 v81, v81, v29
    v_mov_b32 v28, v80
    v_mov_b32 v29, v81
    s_nop 0
    v_permlane32_swap_b32 v28, v80
    v_permlane32_swap_b32 v29, v81
    s_nop 0
    v_add_f32 v80, v80, v28
    v_add_f32 v81, v81, v29
    v_cvt_pk_bf16_f32 v28, v80, v81
    s_mov_b64 exec, 0xf
    buffer_store_dword v28, v236, s[48:51], s90 offen
    s_or_b32 s56, s20, s21
    s_or_b32 s56, s56, s22
    s_cmp_lg_u32 s56, 0
    s_cbranch_scc1 L_fin
    v_mov_b32 v28, s60
    v_mov_b32 v4, 0
    s_mov_b32 s56, 1310720
    s_mov_b64 exec, 1
    buffer_store_dword v28, v4, s[44:47], s56 offen sc1
L_fin:
L_end:
    s_endpgm
.section .rodata,"a"
.p2align 6
.amdhsa_kernel standalone__gqa_block_cached__decode_kernel
  .amdhsa_next_free_vgpr 256
  .amdhsa_next_free_sgpr 96
  .amdhsa_accum_offset 256
  .amdhsa_group_segment_fixed_size 0
  .amdhsa_kernarg_size 64
  .amdhsa_user_sgpr_count 2
  .amdhsa_user_sgpr_kernarg_segment_ptr 1
  .amdhsa_system_sgpr_workgroup_id_x 1
.end_amdhsa_kernel
```
